```python
import torch

def _softmax(x, axis=-1):
    return torch.softmax(x, dim=axis)
def _gelu(x):
    return torch.nn.functional.gelu(x, approximate="tanh")
def _silu(x):
    return torch.nn.functional.silu(x)
def _sigmoid(x):
    return torch.sigmoid(x)
def _layernorm(x, axis=-1, eps=1e-5):
    m = x.mean(dim=axis, keepdim=True)
    v = x.var(dim=axis, keepdim=True, unbiased=False)
    return (x - m) / torch.sqrt(v + eps)
def _scatter_add(tgt, idx, src, axis=0):
    return tgt.clone().index_add_(axis, idx, src)
def _segment_sum(src, seg, n):
    out = torch.zeros((n,) + src.shape[1:], dtype=src.dtype)
    return out.index_add_(0, seg, src)
def _pad(x, pw):
    flat = tuple(v for pair in reversed(pw) for v in pair)
    return torch.nn.functional.pad(x, flat)

kernel_name = 'interleave_layers__linear_kernel_hedgehog__mixer_channel_mlp__prompt'

def setup_inputs():

    _w = (lambda a: (lambda t: t.to(torch.bfloat16) if t.is_floating_point() else t)(torch.as_tensor(a)))
    def _A_setup():
        B, S, D, H = 1, 2048, 640, 32
        Dh = D // H
        return {
            "x": _w((lambda *s: torch.randn(*s, dtype=torch.bfloat16) * 0.05)(B, S, D)),
            "wqkv": _w((lambda *s: torch.randn(*s, dtype=torch.bfloat16) * 0.4)(D, 3 * D)),
            "w_phi": _w((lambda *s: torch.randn(*s, dtype=torch.bfloat16) * 0.4)(H, Dh, Dh) * (Dh ** -0.5)),
            "wo": _w((lambda *s: torch.randn(*s, dtype=torch.bfloat16) * 0.05)(D, D)),
        }
    _A_in = _A_setup()

    def _B_setup():
        B, S, D, F = 1, 2048, 640, 1536
        return {
            "x": _w((lambda *s: torch.randn(*s, dtype=torch.bfloat16) * 0.05)(B, S, D)),
            "w1": _w((lambda *s: torch.randn(*s, dtype=torch.bfloat16) * 3.2)(D, F) * (D ** -0.5)),
            "b1": _w((lambda *s: torch.randn(*s, dtype=torch.bfloat16) * 0.8)(F)),
            "w2": _w((lambda *s: torch.randn(*s, dtype=torch.bfloat16) * 0.8)(F, D) * (F ** -0.5)),
            "b2": _w((lambda *s: torch.randn(*s, dtype=torch.bfloat16) * 0.8)(D)),
        }
    _B_in = _B_setup()

    return {
        "A_x": _A_in["x"],
        "A_wqkv": _A_in["wqkv"],
        "A_w_phi": _A_in["w_phi"],
        "A_wo": _A_in["wo"],
        "B_x": _B_in["x"],
        "B_w1": _B_in["w1"],
        "B_b1": _B_in["b1"],
        "B_w2": _B_in["w2"],
        "B_b2": _B_in["b2"],
    }

def reference(A_x, A_wqkv, A_w_phi, A_wo, B_x, B_w1, B_b1, B_w2, B_b2):
    def _A_ref(x, wqkv, w_phi, wo):
        B, S, D = x.shape
        H = 32; Dh = D // H
        qkv = (lambda x, *d: x.permute(*d))((x @ wqkv).reshape(B, S, 3, H, Dh), 2, 0, 3, 1, 4)
        q, k, v = qkv[0], qkv[1], qkv[2]
        pq = torch.einsum("bhsd,hdf->bhsf", q, w_phi)
        pk = torch.einsum("bhsd,hdf->bhsf", k, w_phi)
        phi_q = torch.concatenate([_softmax(pq, axis=-1), _softmax(-pq, axis=-1)], axis=-1)
        phi_k = torch.concatenate([_softmax(pk, axis=-1), _softmax(-pk, axis=-1)], axis=-1)
        kv = torch.einsum("bhsf,bhsd->bhfd", phi_k, v)
        z  = torch.einsum("bhsf->bhf", phi_k)
        num = torch.einsum("bhqf,bhfd->bhqd", phi_q, kv)
        den = torch.einsum("bhqf,bhf->bhq", phi_q, z)[..., None] + 1e-6
        o = num / den
        return (lambda x, *d: x.permute(*d))(o, 0, 2, 1, 3).reshape(B, S, D) @ wo

    def _B_ref(x, w1, b1, w2, b2):
        y = _layernorm(x, axis=-1)
        h = _gelu(torch.einsum("bsd,df->bsf", y, w1) + b1)
        return torch.einsum("bsf,fd->bsd", h, w2) + b2

    x = A_x
    x = x + _A_ref(_layernorm(x, axis=-1), A_wqkv, A_w_phi, A_wo)
    x = x + _B_ref(_layernorm(x, axis=-1), B_w1, B_b1, B_w2, B_b2)
    x = x + _A_ref(_layernorm(x, axis=-1), A_wqkv, A_w_phi, A_wo)
    x = x + _B_ref(_layernorm(x, axis=-1), B_w1, B_b1, B_w2, B_b2)
    return x
```

```asm
; @launch grid=(256,1,1) block=(256,1,1) lds=163840
.amdgcn_target "amdgcn-amd-amdhsa--gfx950"
.text
.globl interleave_layers__linear_kernel_hedgehog__mixer_channel_mlp__prompt_kernel
.p2align 8
.type interleave_layers__linear_kernel_hedgehog__mixer_channel_mlp__prompt_kernel,@function
interleave_layers__linear_kernel_hedgehog__mixer_channel_mlp__prompt_kernel:
s_cmp_ge_u32 s2, 256
s_cbranch_scc1 L_end
s_load_dwordx16 s[8:23], s[0:1], 0
s_load_dwordx8 s[24:31], s[0:1], 64
s_cmp_lt_u32 s2, 16
s_cbranch_scc0 Lcp0_1
s_getpc_b64 s[56:57]
Lcp0h_2:
v_lshlrev_b32 v168, 7, v0
v_min_u32 v168, L_end-Lcp0h_2-4, v168
global_load_dword v61, v168, s[56:57]
s_nop 3
Lcp0_1:
v_and_b32 v1, 63, v0
v_lshrrev_b32 v168, 6, v0
s_nop 0
v_readfirstlane_b32 s40, v168
v_and_b32 v2, 31, v1
v_lshrrev_b32 v3, 5, v1
v_and_b32 v4, 15, v1
v_lshrrev_b32 v5, 4, v1
v_lshlrev_b32 v6, 4, v1
v_mov_b32 v10, 0
v_mov_b32 v11, 1
v_lshlrev_b32 v60, 7, v1
s_and_b32 s56, s2, 7
s_lshr_b32 s57, s2, 3
s_and_b32 s58, s57, 1
s_lshl_b32 s56, s56, 1
s_add_u32 s41, s56, s58
s_lshr_b32 s42, s57, 1
s_lshr_b32 s43, s42, 3
s_and_b32 s44, s42, 7
s_and_b32 s45, s40, 1
s_lshr_b32 s46, s40, 1
s_mov_b32 s51, 0x80000000
s_mov_b32 s52, 0x3f803f80
s_mov_b32 s53, 0
s_mov_b32 s47, 0
s_mov_b32 s87, 0
s_lshl_b32 s50, s41, 7
s_lshl_b32 s56, s43, 6
s_add_u32 s50, s50, s56
s_lshl_b32 s56, s45, 5
s_add_u32 s50, s50, s56
s_lshl_b32 s56, s46, 4
s_add_u32 s50, s50, s56
s_and_b32 s56, s41, 3
s_lshr_b32 s57, s41, 2
s_mul_i32 s59, s41, 43
s_lshr_b32 s59, s59, 7
s_mul_i32 s58, s59, 3
s_sub_u32 s58, s41, s58
v_lshrrev_b32 v169, 2, v1
v_and_b32 v170, 3, v1
s_lshl_b32 s60, s56, 2
v_add_u32 v180, s60, v170
v_min_u32 v180, 14, v180
v_cmp_le_u32 vcc, 5, v180
s_nop 1
v_cndmask_b32 v181, 0, 1, vcc
v_cmp_le_u32 vcc, 10, v180
s_nop 1
v_cndmask_b32 v182, 0, 1, vcc
v_add_u32 v181, v181, v182
v_mul_u32_u24 v182, 5, v181
v_sub_u32 v180, v180, v182
v_lshlrev_b32 v180, 4, v180
v_add_u32 v181, 1, v181
v_mul_u32_u24 v181, 1280, v181
v_mov_b32 v182, 0
v_cndmask_b32 v181, v181, v182, vcc
v_add_u32 v180, v180, v181
s_mul_i32 s60, s42, 80
v_add_u32 v180, s60, v180
v_mul_u32_u24 v171, 3840, v169
v_add_u32 v171, v171, v180
v_mul_u32_u24 v179, 1280, v4
v_lshlrev_b32 v180, 3, v5
v_add_u32 v179, v179, v180
s_waitcnt lgkmcnt(0)
s_mov_b32 s32, s30
s_mov_b32 s33, s31
s_mov_b32 s34, 0x10000000
s_mov_b32 s35, 0x20000
s_or_b32 s60, s42, s40
s_cmp_eq_u32 s60, 0
s_cbranch_scc0 Linit_3
s_lshl_b32 s60, s41, 8
v_lshlrev_b32 v180, 2, v1
buffer_store_dword v10, v180, s[32:35], s60 offen sc1
s_add_u32 s60, s60, 8192
buffer_store_dword v10, v180, s[32:35], s60 offen sc1
s_add_u32 s60, s60, 8192
buffer_store_dword v10, v180, s[32:35], s60 offen sc1
s_add_u32 s60, s60, 8192
buffer_store_dword v10, v180, s[32:35], s60 offen sc1
Linit_3:
s_mov_b32 s36, s8
s_mov_b32 s37, s9
s_mov_b32 s38, 2621440
s_mov_b32 s39, 0x20000
s_mul_i32 s60, s50, 1280
s_mul_i32 s61, s44, 160
s_add_u32 s60, s60, s61
buffer_load_dwordx2 v[180:181], v179, s[36:39], s60 offen offset:0
buffer_load_dwordx2 v[182:183], v179, s[36:39], s60 offen offset:32
buffer_load_dwordx2 v[184:185], v179, s[36:39], s60 offen offset:64
buffer_load_dwordx2 v[186:187], v179, s[36:39], s60 offen offset:96
buffer_load_dwordx2 v[188:189], v179, s[36:39], s60 offen offset:128
s_mul_i32 s62, s40, 9216
s_add_u32 s62, s62, 10240
s_mov_b32 s36, s10
s_mov_b32 s37, s11
s_mov_b32 s38, 2457600
s_mov_b32 s39, 0x20000
s_mul_i32 s63, s57, 10
s_add_u32 s63, s63, s40
s_add_u32 s60, s63, 0
s_mul_i32 s60, s60, 61440
s_mov_b32 m0, s62
s_add_u32 s62, s62, 1024
buffer_load_dwordx4 v171, s[36:39], s60 offen lds
s_add_u32 s60, s63, 4
s_mul_i32 s60, s60, 61440
s_mov_b32 m0, s62
s_add_u32 s62, s62, 1024
buffer_load_dwordx4 v171, s[36:39], s60 offen lds
s_add_u32 s60, s63, 8
s_min_u32 s60, s60, 39
s_mul_i32 s60, s60, 61440
s_mov_b32 m0, s62
s_add_u32 s62, s62, 1024
buffer_load_dwordx4 v171, s[36:39], s60 offen lds
s_mov_b32 s36, s12
s_mov_b32 s37, s13
s_mov_b32 s38, 25600
s_mov_b32 s39, 0x20000
s_mul_i32 s60, s42, 1600
s_lshl_b32 s61, s40, 10
s_add_u32 s60, s60, s61
s_add_u32 s61, s61, 2048
s_cmp_lt_u32 s40, 2
s_cselect_b32 m0, s61, 0x30000
s_nop 0
buffer_load_dwordx4 v6, s[36:39], s60 offen lds
s_or_b32 s60, s42, s40
s_cmp_eq_u32 s60, 0
s_cbranch_scc0 Linit2_4
s_waitcnt vmcnt(9)
s_lshl_b32 s60, s41, 2
v_mov_b32 v194, s60
s_mov_b64 exec, 1
global_store_dword v194, v11, s[28:29] sc1
s_mov_b64 exec, -1
s_nop 1
Linit2_4:
s_lshl_b32 s84, s41, 8
s_lshl_b32 s3, s42, 2
s_add_u32 s3, s3, s40
s_lshl_b32 s3, s3, 2
s_add_u32 s3, s3, s84
s_add_u32 s3, s3, 16384
s_mov_b32 s83, 0
s_lshl_b32 s85, s42, 8
s_add_u32 s85, s85, 8192
s_xor_b32 s86, s42, 8
s_lshl_b32 s86, s86, 8
s_add_u32 s86, s86, 8192
s_mul_i32 s48, s41, 163840
s_lshl_b32 s91, s43, 1
s_add_u32 s91, s91, s45
s_mul_i32 s91, s91, 40960
s_add_u32 s48, s48, s91
s_mul_i32 s91, s44, 5120
s_add_u32 s48, s48, s91
s_lshl_b32 s49, s44, 14
s_lshl_b32 s91, s50, 3
s_add_u32 s49, s49, s91
v_lshrrev_b32 v64, 1, v5
v_lshlrev_b32 v64, 5, v64
s_lshl_b32 s91, s46, 4
v_add_u32 v64, s91, v64
v_add_u32 v64, v64, v4
v_lshlrev_b32 v64, 4, v64
v_and_b32 v65, 1, v5
v_lshlrev_b32 v66, 3, v65
v_add_u32 v8, v64, v66
v_add_u32 v8, 0x1000, v8
v_xor_b32 v65, 1, v65
v_lshlrev_b32 v65, 10, v65
v_add_u32 v7, v64, v65
v_lshlrev_b32 v9, 3, v4
v_cmp_eq_u32 vcc, 0, v5
v_mov_b32 v64, s51
s_nop 0
v_cndmask_b32 v9, v64, v9, vcc
s_mul_i32 s60, s42, 192
s_lshl_b32 s61, s58, 6
s_add_u32 s60, s60, s61
v_mul_u32_u24 v172, 3072, v169
v_lshlrev_b32 v76, 4, v170
v_add_u32 v172, v172, v76
v_add_u32 v172, s60, v172
v_lshrrev_b32 v76, 4, v1
v_bfe_u32 v77, v1, 1, 3
v_and_b32 v78, 1, v1
v_lshlrev_b32 v78, 4, v78
v_lshrrev_b32 v79, 1, v76
v_and_b32 v80, 1, v76
v_lshrrev_b32 v81, 2, v77
v_and_b32 v82, 3, v77
v_lshlrev_b32 v83, 4, v79
v_lshl_add_u32 v83, v81, 3, v83
v_lshl_add_u32 v83, v80, 2, v83
v_add_u32 v83, v83, v82
v_mul_u32_u24 v173, 1280, v83
v_add_u32 v173, v173, v78
v_mul_u32_u24 v83, 20, v79
v_lshl_add_u32 v83, v80, 3, v83
v_add_u32 v83, v83, v77
v_mul_u32_u24 v174, 1280, v83
v_add_u32 v174, v174, v78
v_mul_u32_u24 v83, 40, v76
v_mul_u32_u24 v84, 20, v81
v_add3_u32 v83, v83, v84, v82
v_add_u32 v83, 16, v83
v_mul_u32_u24 v175, 1280, v83
v_add_u32 v175, v175, v78
v_lshrrev_b32 v76, 2, v4
v_and_b32 v77, 3, v4
v_lshlrev_b32 v77, 3, v77
v_lshl_add_u32 v78, v3, 3, v76
v_lshlrev_b32 v78, 6, v78
v_and_b32 v79, 1, v5
v_lshl_add_u32 v78, v79, 5, v78
v_add_u32 v176, v78, v77
v_lshl_add_u32 v78, v5, 3, v76
v_lshlrev_b32 v78, 5, v78
v_add_u32 v177, v78, v77
s_mul_i32 s60, s40, 9216
s_add_u32 s60, s60, 10240
v_add_u32 v176, s60, v176
v_add_u32 v177, s60, v177
v_mul_u32_u24 v76, 24, v3
v_add_u32 v76, v76, v2
v_lshlrev_b32 v76, 4, v76
v_mov_b32 v77, s51
v_cmp_le_u32 vcc, 24, v2
s_nop 1
v_cndmask_b32 v76, v76, v77, vcc
s_cmp_eq_u32 s56, 3
s_cselect_b64 vcc, -1, 0
v_cndmask_b32 v178, v6, v76, vcc
s_cmp_eq_u32 s40, 0
s_nop 3
s_cbranch_scc0 Lcpf_5
s_getpc_b64 s[66:67]
Lcph_6:
s_lshr_b32 s91, s2, 3
s_lshl_b32 s91, s91, 11
v_lshlrev_b32 v192, 7, v4
v_add_u32 v192, s91, v192
v_cmp_gt_u32 vcc, L_end-Lcph_6, v192
s_nop 3
s_and_saveexec_b64 s[80:81], vcc
s_cbranch_execz Lcph_6_x
global_load_dword v61, v192, s[66:67]
Lcph_6_x:
s_mov_b64 exec, s[80:81]
Lcpf_5:
s_lshl_b32 s91, s40, 5
v_add_u32 v228, s91, v2
v_mul_u32_u24 v229, 160, v228
v_mul_u32_u24 v230, 80, v3
v_add_u32 v229, v229, v230
v_accvgpr_write_b32 a220, v229
v_mul_u32_u24 v229, 96, v228
v_lshlrev_b32 v230, 3, v3
v_add_u32 v229, v229, v230
v_add_u32 v229, 143360, v229
v_accvgpr_write_b32 a221, v229
v_lshrrev_b32 v230, 2, v4
v_lshlrev_b32 v231, 2, v5
v_add_u32 v230, v230, v231
v_and_b32 v231, 3, v4
v_mul_u32_u24 v228, 160, v230
v_lshlrev_b32 v232, 3, v231
v_add_u32 v228, v228, v232
s_mul_i32 s91, s46, 80
v_add_u32 v228, s91, v228
v_accvgpr_write_b32 a222, v228
v_mul_u32_u24 v229, 96, v230
s_mul_i32 s91, s46, 40
v_add_u32 v233, s91, v232
s_add_u32 s91, s91, 32
v_mov_b32 v234, s91
v_mov_b32 v235, 80
v_cmp_eq_u32 vcc, 1, v231
s_nop 1
v_cndmask_b32 v234, v234, v235, vcc
v_mov_b32 v235, 88
v_cmp_le_u32 vcc, 2, v231
s_nop 1
v_cndmask_b32 v234, v234, v235, vcc
s_cmp_eq_u32 s45, 1
s_cselect_b64 vcc, -1, 0
v_cndmask_b32 v233, v233, v234, vcc
v_add_u32 v229, v229, v233
v_add_u32 v229, 143360, v229
v_accvgpr_write_b32 a223, v229
s_lshl_b32 s91, s45, 4
v_add_u32 v230, s91, v4
v_mul_u32_u24 v231, 80, v230
v_lshlrev_b32 v232, 3, v5
v_add_u32 v231, v231, v232
s_mul_i32 s91, s46, 1680
v_add_u32 v231, s91, v231
v_mov_b32 v233, s51
v_cmp_lt_u32 vcc, 20, v230
s_nop 1
v_cndmask_b32 v231, v231, v233, vcc
v_cmp_le_u32 vcc, 2, v5
s_nop 1
v_cndmask_b32 v232, v231, v233, vcc
v_accvgpr_write_b32 a224, v231
v_accvgpr_write_b32 a225, v232
v_lshlrev_b32 v228, 4, v0
v_cmp_gt_u32 vcc, 210, v0
s_nop 1
v_cndmask_b32 v228, v233, v228, vcc
v_accvgpr_write_b32 a228, v228
s_lshl_b32 s91, s40, 6
s_add_u32 s91, s91, 0
v_add_u32 v228, s91, v2
v_lshlrev_b32 v229, 4, v228
v_lshlrev_b32 v230, 3, v3
v_add_u32 v229, v229, v230
v_add_u32 v229, 2048, v229
v_mov_b32 v230, 7296
v_cmp_gt_u32 vcc, 210, v228
s_nop 1
v_cndmask_b32 v229, v230, v229, vcc
v_accvgpr_write_b32 a226, v229
s_lshl_b32 s91, s40, 6
s_add_u32 s91, s91, 32
v_add_u32 v228, s91, v2
v_lshlrev_b32 v229, 4, v228
v_lshlrev_b32 v230, 3, v3
v_add_u32 v229, v229, v230
v_add_u32 v229, 2048, v229
v_mov_b32 v230, 7296
v_cmp_gt_u32 vcc, 210, v228
s_nop 1
v_cndmask_b32 v229, v230, v229, vcc
v_accvgpr_write_b32 a227, v229
v_lshrrev_b32 v232, 2, v2
v_and_b32 v233, 1, v232
v_lshrrev_b32 v232, 1, v232
v_and_b32 v234, 3, v2
v_lshlrev_b32 v235, 2, v232
v_add_u32 v235, v235, v234
v_mul_u32_u24 v236, 1680, v233
v_add_u32 v236, 2048, v236
v_mul_u32_u24 v237, 80, v235
v_add_u32 v228, v236, v237
v_add_u32 v229, 1280, v228
v_mov_b32 v238, 5632
v_cmp_le_u32 vcc, 5, v235
s_nop 1
v_cndmask_b32 v229, v229, v238, vcc
v_cmp_ne_u32 vcc, v233, v3
s_nop 1
v_cndmask_b32 v228, v228, v238, vcc
v_cndmask_b32 v229, v229, v238, vcc
v_accvgpr_write_b32 a229, v228
v_accvgpr_write_b32 a230, v229
v_lshrrev_b32 v228, 4, v2
v_mul_u32_u24 v228, 20480, v228
v_lshlrev_b32 v229, 4, v4
v_add_u32 v228, v228, v229
v_lshlrev_b32 v229, 9, v3
v_add_u32 v229, v228, v229
v_lshlrev_b32 v230, 3, v3
v_add_u32 v230, v228, v230
v_accvgpr_write_b32 a231, v229
v_accvgpr_write_b32 a232, v230
v_subrev_u32 v228, 4, v2
v_subrev_u32 v229, 12, v2
v_cmp_le_u32 vcc, 28, v2
s_nop 1
v_cndmask_b32 v228, v228, v229, vcc
v_cmp_le_u32 vcc, 24, v2
s_nop 1
v_cndmask_b32 v228, v2, v228, vcc
v_mul_u32_u24 v229, 24, v3
v_add_u32 v228, v228, v229
v_lshlrev_b32 v228, 4, v228
v_add_u32 v228, 71680, v228
v_accvgpr_write_b32 a233, v228
v_lshrrev_b32 v228, 4, v2
v_mul_u32_u24 v228, 49152, v228
v_lshlrev_b32 v229, 4, v4
v_add_u32 v228, v228, v229
v_lshlrev_b32 v229, 8, v3
v_add_u32 v228, v228, v229
v_accvgpr_write_b32 a234, v228
v_lshlrev_b32 v228, 16, v3
v_lshlrev_b32 v229, 3, v2
v_add_u32 v228, v228, v229
s_lshl_b32 s91, s41, 10
v_add_u32 v228, s91, v228
s_lshl_b32 s91, s40, 8
v_add_u32 v228, s91, v228
v_accvgpr_write_b32 a235, v228
v_mov_b32 v228, s85
v_mov_b32 v229, s86
v_cmp_eq_u32 vcc, 1, v1
s_nop 1
v_cndmask_b32 v228, v228, v229, vcc
v_accvgpr_write_b32 a236, v228
v_lshlrev_b32 v228, 2, v0
v_mov_b32 v229, 6784
v_cmp_gt_u32 vcc, 128, v0
s_nop 1
v_cndmask_b32 v228, v229, v228, vcc
v_accvgpr_write_b32 a237, v228
v_lshrrev_b32 v228, 3, v2
v_cmp_eq_u32 vcc, v228, v3
v_and_b32 v229, 1, v2
v_lshlrev_b32 v229, 4, v229
v_mov_b32 v230, 0x3f80
v_lshlrev_b32 v230, v229, v230
v_cndmask_b32 v230, 0, v230, vcc
v_bfe_u32 v231, v2, 1, 2
v_cmp_eq_u32 vcc, 0, v231
s_nop 1
v_cndmask_b32 v232, 0, v230, vcc
v_accvgpr_write_b32 a216, v232
v_cmp_eq_u32 vcc, 1, v231
s_nop 1
v_cndmask_b32 v232, 0, v230, vcc
v_accvgpr_write_b32 a217, v232
v_cmp_eq_u32 vcc, 2, v231
s_nop 1
v_cndmask_b32 v232, 0, v230, vcc
v_accvgpr_write_b32 a218, v232
v_cmp_eq_u32 vcc, 3, v231
s_nop 1
v_cndmask_b32 v232, 0, v230, vcc
v_accvgpr_write_b32 a219, v232
s_add_u32 s60, s63, 0
s_mul_i32 s88, s60, 3072
s_lshl_b32 s66, s56, 10
s_add_u32 s88, s88, s66
s_mul_i32 s66, s60, 768
s_add_u32 s66, s66, 122880
s_cmp_eq_u32 s56, 3
s_cselect_b32 s88, s66, s88
s_mul_i32 s66, s42, 153600
s_add_u32 s88, s88, s66
s_add_u32 s88, s88, 4194304
s_add_u32 s60, s63, 4
s_mul_i32 s89, s60, 3072
s_lshl_b32 s66, s56, 10
s_add_u32 s89, s89, s66
s_mul_i32 s66, s60, 768
s_add_u32 s66, s66, 122880
s_cmp_eq_u32 s56, 3
s_cselect_b32 s89, s66, s89
s_mul_i32 s66, s42, 153600
s_add_u32 s89, s89, s66
s_add_u32 s89, s89, 4194304
s_add_u32 s60, s63, 8
s_mul_i32 s90, s60, 3072
s_lshl_b32 s66, s56, 10
s_add_u32 s90, s90, s66
s_mul_i32 s66, s60, 768
s_add_u32 s66, s66, 122880
s_cmp_eq_u32 s56, 3
s_cselect_b32 s90, s66, s90
s_mul_i32 s66, s42, 153600
s_add_u32 s90, s90, s66
s_add_u32 s90, s90, 4194304
v_lshlrev_b32 v220, 2, v1
v_cmp_gt_u32 vcc, 32, v0
s_nop 3
s_and_saveexec_b64 s[80:81], vcc
s_cbranch_execz Lz_7
ds_write_b32 v220, v10 offset:5632
Lz_7:
s_mov_b64 exec, s[80:81]
s_waitcnt vmcnt(4)
v_lshlrev_b32 v16, 16, v180
v_and_b32 v17, 0xffff0000, v180
v_lshlrev_b32 v18, 16, v181
v_and_b32 v19, 0xffff0000, v181
v_lshlrev_b32 v20, 16, v182
v_and_b32 v21, 0xffff0000, v182
v_lshlrev_b32 v22, 16, v183
v_and_b32 v23, 0xffff0000, v183
v_lshlrev_b32 v24, 16, v184
v_and_b32 v25, 0xffff0000, v184
v_lshlrev_b32 v26, 16, v185
v_and_b32 v27, 0xffff0000, v185
v_lshlrev_b32 v28, 16, v186
v_and_b32 v29, 0xffff0000, v186
v_lshlrev_b32 v30, 16, v187
v_and_b32 v31, 0xffff0000, v187
v_lshlrev_b32 v32, 16, v188
v_and_b32 v33, 0xffff0000, v188
v_lshlrev_b32 v34, 16, v189
v_and_b32 v35, 0xffff0000, v189
s_add_u32 s60, s48, 16777216
s_add_u32 s61, s49, 3145728
v_cvt_pk_bf16_f32 v196, v20, v21
v_cvt_pk_bf16_f32 v197, v22, v23
v_cvt_pk_bf16_f32 v198, v16, v17
v_cvt_pk_bf16_f32 v199, v18, v19
v_cvt_pk_bf16_f32 v200, v28, v29
v_cvt_pk_bf16_f32 v201, v30, v31
v_cvt_pk_bf16_f32 v202, v24, v25
v_cvt_pk_bf16_f32 v203, v26, v27
v_cvt_pk_bf16_f32 v204, v32, v33
v_cvt_pk_bf16_f32 v205, v34, v35
v_permlane16_swap_b32 v196, v198
v_permlane16_swap_b32 v197, v199
v_permlane16_swap_b32 v200, v202
v_permlane16_swap_b32 v201, v203
buffer_store_dwordx4 v[196:199], v7, s[32:35], s60 offen sc1
buffer_store_dwordx4 v[200:203], v7, s[32:35], s60 offen offset:2048 sc1
buffer_store_dwordx2 v[204:205], v8, s[32:35], s60 offen sc1
v_pk_add_f32 v[206:207], v[16:17], v[18:19]
v_pk_mul_f32 v[208:209], v[16:17], v[16:17]
v_pk_fma_f32 v[208:209], v[18:19], v[18:19], v[208:209]
v_pk_add_f32 v[206:207], v[206:207], v[20:21]
v_pk_fma_f32 v[208:209], v[20:21], v[20:21], v[208:209]
v_pk_add_f32 v[206:207], v[206:207], v[22:23]
v_pk_fma_f32 v[208:209], v[22:23], v[22:23], v[208:209]
v_pk_add_f32 v[206:207], v[206:207], v[24:25]
v_pk_fma_f32 v[208:209], v[24:25], v[24:25], v[208:209]
v_pk_add_f32 v[206:207], v[206:207], v[26:27]
v_pk_fma_f32 v[208:209], v[26:27], v[26:27], v[208:209]
v_pk_add_f32 v[206:207], v[206:207], v[28:29]
v_pk_fma_f32 v[208:209], v[28:29], v[28:29], v[208:209]
v_pk_add_f32 v[206:207], v[206:207], v[30:31]
v_pk_fma_f32 v[208:209], v[30:31], v[30:31], v[208:209]
v_pk_add_f32 v[206:207], v[206:207], v[32:33]
v_pk_fma_f32 v[208:209], v[32:33], v[32:33], v[208:209]
v_pk_add_f32 v[206:207], v[206:207], v[34:35]
v_pk_fma_f32 v[208:209], v[34:35], v[34:35], v[208:209]
v_add_f32 v206, v206, v207
v_add_f32 v207, v208, v209
v_mov_b32 v208, v206
v_mov_b32 v209, v207
s_nop 0
v_permlane16_swap_b32 v206, v208
v_permlane16_swap_b32 v207, v209
v_add_f32 v206, v206, v208
v_add_f32 v207, v207, v209
v_mov_b32 v208, v206
v_mov_b32 v209, v207
s_nop 0
v_permlane32_swap_b32 v206, v208
v_permlane32_swap_b32 v207, v209
v_add_f32 v206, v206, v208
v_add_f32 v207, v207, v209
buffer_store_dwordx2 v[206:207], v9, s[32:35], s61 offen sc1
v_mov_b32 v194, 0
v_mov_b32 v195, 0
s_waitcnt vmcnt(5)
ds_read_b64_tr_b16 v[212:213], v176 offset:0
ds_read_b64_tr_b16 v[214:215], v176 offset:256
s_waitcnt lgkmcnt(0)
v_dot2_f32_bf16 v194, v212, s52, v194
v_dot2_f32_bf16 v194, v213, s52, v194
v_dot2_f32_bf16 v194, v214, s52, v194
v_dot2_f32_bf16 v194, v215, s52, v194
buffer_store_dwordx4 v[212:215], v178, s[32:35], s88 offen sc1
ds_read_b64_tr_b16 v[216:217], v176 offset:1024
ds_read_b64_tr_b16 v[218:219], v176 offset:1280
s_waitcnt lgkmcnt(0)
v_dot2_f32_bf16 v194, v216, s52, v194
v_dot2_f32_bf16 v194, v217, s52, v194
v_dot2_f32_bf16 v194, v218, s52, v194
v_dot2_f32_bf16 v194, v219, s52, v194
buffer_store_dwordx4 v[216:219], v178, s[32:35], s89 offen sc1
s_cmp_lt_u32 s40, 2
s_nop 2
s_cbranch_scc0 Lq3_8
ds_read_b64_tr_b16 v[212:213], v176 offset:2048
ds_read_b64_tr_b16 v[214:215], v176 offset:2304
s_waitcnt lgkmcnt(0)
v_dot2_f32_bf16 v194, v212, s52, v194
v_dot2_f32_bf16 v194, v213, s52, v194
v_dot2_f32_bf16 v194, v214, s52, v194
v_dot2_f32_bf16 v194, v215, s52, v194
buffer_store_dwordx4 v[212:215], v178, s[32:35], s90 offen sc1
s_nop 3
Lq3_8:
v_lshlrev_b32 v220, 2, v0
ds_write_b32 v220, v194 offset:5760
s_cmp_eq_u32 s40, 0
s_nop 2
s_cbranch_scc0 Ldb_9
v_lshlrev_b32 v218, 2, v4
global_load_dword v219, v218, s[28:29] sc1
s_nop 3
Ldb_9:
s_waitcnt vmcnt(0)
s_waitcnt lgkmcnt(0)
s_barrier
s_mov_b32 s11, 0
s_cmp_eq_u32 s40, 0
s_cbranch_scc0 Lini2_10
s_lshl_b32 s66, 1, s41
s_lshl_b32 s67, 1, s42
s_or_b32 s66, s66, s67
s_xor_b32 s67, s42, 8
s_lshl_b32 s67, 1, s67
s_or_b32 s66, s66, s67
s_mov_b32 s82, 0
s_branch Lip_12_chk
Lip_12:
global_load_dword v219, v218, s[28:29] sc1
Lip_12_chk:
s_add_u32 s82, s82, 1
s_cmp_gt_u32 s82, 6000000
s_cbranch_scc1 Lid_11_to
s_waitcnt vmcnt(0)
v_cmp_ne_u32 vcc, 1, v219
s_nop 3
s_and_b32 s91, s66, vcc_lo
s_cmp_eq_u32 s91, 0
s_cbranch_scc1 Lid_11
s_branch Lip_12
Lid_11_to:
s_or_b32 s53, s53, 2
s_waitcnt vmcnt(0)
Lid_11:
s_mov_b64 exec, 1
s_getreg_b32 s60, hwreg(HW_REG_XCC_ID)
s_and_b32 s60, s60, 15
s_mul_i32 s61, s60, s60
s_lshl_b32 s61, s61, 16
s_lshl_b32 s60, s60, 8
s_add_u32 s60, s60, s61
s_add_u32 s60, s60, 1
v_mov_b32 v219, s60
v_mov_b32 v218, s84
global_atomic_add v218, v219, s[30:31] sc1
v_mov_b32 v218, s85
global_atomic_add v218, v11, s[30:31] sc1
s_mov_b64 exec, -1
s_nop 2
Lini2_10:
s_mov_b32 s36, s18
s_mov_b32 s37, s19
s_mov_b32 s38, 1966080
s_mov_b32 s39, 0x20000
s_min_u32 s59, s59, 3
s_mul_i32 s64, s59, 10
s_add_u32 s64, s64, s40
s_add_u32 s60, s64, 0
s_mul_i32 s60, s60, 49152
s_mov_b32 m0, s62
s_add_u32 s62, s62, 1024
buffer_load_dwordx4 v172, s[36:39], s60 offen lds
s_add_u32 s60, s64, 4
s_mul_i32 s60, s60, 49152
s_mov_b32 m0, s62
s_add_u32 s62, s62, 1024
buffer_load_dwordx4 v172, s[36:39], s60 offen lds
s_add_u32 s60, s64, 8
s_min_u32 s60, s60, 39
s_mul_i32 s60, s60, 49152
s_mov_b32 m0, s62
s_add_u32 s62, s62, 1024
buffer_load_dwordx4 v172, s[36:39], s60 offen lds
s_lshl_b32 s65, s43, 4
s_add_u32 s65, s65, s41
s_lshl_b32 s65, s65, 2
s_add_u32 s65, s65, s40
s_mov_b32 s36, s22
s_mov_b32 s37, s23
s_mov_b32 s38, 1966080
s_mov_b32 s39, 0x20000
s_add_u32 s60, s65, 0
s_mul_i32 s88, s60, 52429
s_lshr_b32 s88, s88, 19
s_mul_i32 s89, s88, 10
s_sub_u32 s89, s60, s89
s_cmp_ge_u32 s89, 5
s_cselect_b32 s90, 1, 0
s_mul_i32 s91, s90, 5
s_sub_u32 s91, s89, s91
s_mul_i32 s90, s90, 24
s_and_b32 s89, s88, 7
s_mul_i32 s89, s89, 3
s_lshr_b32 s88, s88, 3
s_add_u32 s88, s88, s89
s_add_u32 s90, s90, s88
s_mul_i32 s60, s90, 40960
s_mul_i32 s61, s44, 160
s_add_u32 s60, s60, s61
s_lshl_b32 s61, s91, 5
s_add_u32 s60, s60, s61
s_mov_b32 m0, s62
s_add_u32 s62, s62, 1024
buffer_load_dwordx4 v173, s[36:39], s60 offen lds
s_add_u32 s60, s65, 128
s_min_u32 s60, s60, 239
s_mul_i32 s88, s60, 52429
s_lshr_b32 s88, s88, 19
s_mul_i32 s89, s88, 10
s_sub_u32 s89, s60, s89
s_cmp_ge_u32 s89, 5
s_cselect_b32 s90, 1, 0
s_mul_i32 s91, s90, 5
s_sub_u32 s91, s89, s91
s_mul_i32 s90, s90, 24
s_and_b32 s89, s88, 7
s_mul_i32 s89, s89, 3
s_lshr_b32 s88, s88, 3
s_add_u32 s88, s88, s89
s_add_u32 s90, s90, s88
s_mul_i32 s60, s90, 40960
s_mul_i32 s61, s44, 160
s_add_u32 s60, s60, s61
s_lshl_b32 s61, s91, 5
s_add_u32 s60, s60, s61
s_mov_b32 m0, s62
s_add_u32 s62, s62, 1024
buffer_load_dwordx4 v173, s[36:39], s60 offen lds
s_mov_b32 s36, s14
s_mov_b32 s37, s15
s_mov_b32 s38, 819200
s_mov_b32 s39, 0x20000
s_min_u32 s60, s65, 99
s_mul_i32 s88, s60, 52429
s_lshr_b32 s88, s88, 19
s_mul_i32 s89, s88, 10
s_sub_u32 s89, s60, s89
s_cmp_ge_u32 s89, 5
s_cselect_b32 s90, 1, 0
s_mul_i32 s91, s90, 5
s_sub_u32 s91, s89, s91
s_mul_i32 s90, s90, 10
s_add_u32 s90, s90, s88
s_mul_i32 s60, s90, 51200
s_sub_u32 s61, s90, 16
s_mul_i32 s61, s61, 204800
s_cmp_lt_u32 s90, 16
s_cselect_b32 s60, s60, s61
s_cselect_b64 vcc, -1, 0
v_cndmask_b32 v174, v175, v174, vcc
s_mul_i32 s61, s44, 160
s_add_u32 s60, s60, s61
s_lshl_b32 s61, s91, 5
s_add_u32 s60, s60, s61
s_mov_b32 m0, s62
s_add_u32 s62, s62, 1024
buffer_load_dwordx4 v174, s[36:39], s60 offen lds
s_mov_b32 s36, s20
s_mov_b32 s37, s21
s_mov_b32 s38, 3072
s_mov_b32 s39, 0x20000
s_mul_i32 s60, s42, 192
v_lshlrev_b32 v192, 1, v0
buffer_load_ushort v190, v192, s[36:39], s60 offen
s_mov_b32 s36, s24
s_mov_b32 s37, s25
s_mov_b32 s38, 1280
s_mov_b32 s39, 0x20000
s_mul_i32 s60, s44, 160
buffer_load_ushort v191, v192, s[36:39], s60 offen
v_lshrrev_b32 v68, 2, v2
v_and_b32 v69, 1, v68
v_lshrrev_b32 v68, 1, v68
v_and_b32 v70, 3, v2
v_mul_u32_u24 v64, 800, v69
v_lshlrev_b32 v71, 3, v68
v_lshlrev_b32 v72, 1, v70
v_add3_u32 v64, v64, v71, v72
v_add_u32 v64, 2048, v64
v_add_u32 v65, 32, v64
v_mov_b32 v73, 5632
v_cmp_eq_u32 s[80:81], 0, v68
v_add_u32 v71, 0, v3
v_cmp_le_u32 vcc, 5, v71
s_nop 1
v_cndmask_b32 v72, 0, 1, vcc
v_mul_u32_u24 v74, 5, v72
v_sub_u32 v71, v71, v74
v_mul_u32_u24 v71, 160, v71
v_cmp_eq_u32 vcc, v72, v69
v_add_u32 v66, v71, v64
s_nop 0
v_cndmask_b32 v66, v73, v66, vcc
ds_read_u16 v76, v66 offset:0
ds_read_u16 v77, v66 offset:40
ds_read_u16 v78, v66 offset:80
ds_read_u16 v79, v66 offset:120
v_add_u32 v66, v71, v65
v_cndmask_b32 v66, v73, v66, vcc
v_cndmask_b32 v66, v73, v66, s[80:81]
ds_read_u16 v96, v66 offset:0
ds_read_u16 v97, v66 offset:40
ds_read_u16 v98, v66 offset:80
ds_read_u16 v99, v66 offset:120
s_waitcnt lgkmcnt(0)
v_add_u32 v71, 2, v3
v_cmp_le_u32 vcc, 5, v71
s_nop 1
v_cndmask_b32 v72, 0, 1, vcc
v_mul_u32_u24 v74, 5, v72
v_sub_u32 v71, v71, v74
v_mul_u32_u24 v71, 160, v71
v_cmp_eq_u32 vcc, v72, v69
v_add_u32 v66, v71, v64
s_nop 0
v_cndmask_b32 v66, v73, v66, vcc
ds_read_u16 v80, v66 offset:0
ds_read_u16 v81, v66 offset:40
ds_read_u16 v82, v66 offset:80
ds_read_u16 v83, v66 offset:120
v_add_u32 v66, v71, v65
v_cndmask_b32 v66, v73, v66, vcc
v_cndmask_b32 v66, v73, v66, s[80:81]
ds_read_u16 v100, v66 offset:0
ds_read_u16 v101, v66 offset:40
ds_read_u16 v102, v66 offset:80
ds_read_u16 v103, v66 offset:120
s_waitcnt lgkmcnt(0)
v_add_u32 v71, 4, v3
v_cmp_le_u32 vcc, 5, v71
s_nop 1
v_cndmask_b32 v72, 0, 1, vcc
v_mul_u32_u24 v74, 5, v72
v_sub_u32 v71, v71, v74
v_mul_u32_u24 v71, 160, v71
v_cmp_eq_u32 vcc, v72, v69
v_add_u32 v66, v71, v64
s_nop 0
v_cndmask_b32 v66, v73, v66, vcc
ds_read_u16 v84, v66 offset:0
ds_read_u16 v85, v66 offset:40
ds_read_u16 v86, v66 offset:80
ds_read_u16 v87, v66 offset:120
v_add_u32 v66, v71, v65
v_cndmask_b32 v66, v73, v66, vcc
v_cndmask_b32 v66, v73, v66, s[80:81]
ds_read_u16 v104, v66 offset:0
ds_read_u16 v105, v66 offset:40
ds_read_u16 v106, v66 offset:80
ds_read_u16 v107, v66 offset:120
s_waitcnt lgkmcnt(0)
v_add_u32 v71, 6, v3
v_cmp_le_u32 vcc, 5, v71
s_nop 1
v_cndmask_b32 v72, 0, 1, vcc
v_mul_u32_u24 v74, 5, v72
v_sub_u32 v71, v71, v74
v_mul_u32_u24 v71, 160, v71
v_cmp_eq_u32 vcc, v72, v69
v_add_u32 v66, v71, v64
s_nop 0
v_cndmask_b32 v66, v73, v66, vcc
ds_read_u16 v88, v66 offset:0
ds_read_u16 v89, v66 offset:40
ds_read_u16 v90, v66 offset:80
ds_read_u16 v91, v66 offset:120
v_add_u32 v66, v71, v65
v_cndmask_b32 v66, v73, v66, vcc
v_cndmask_b32 v66, v73, v66, s[80:81]
ds_read_u16 v108, v66 offset:0
ds_read_u16 v109, v66 offset:40
ds_read_u16 v110, v66 offset:80
ds_read_u16 v111, v66 offset:120
s_waitcnt lgkmcnt(0)
v_add_u32 v71, 8, v3
v_cmp_le_u32 vcc, 5, v71
s_nop 1
v_cndmask_b32 v72, 0, 1, vcc
v_mul_u32_u24 v74, 5, v72
v_sub_u32 v71, v71, v74
v_mul_u32_u24 v71, 160, v71
v_cmp_eq_u32 vcc, v72, v69
v_add_u32 v66, v71, v64
s_nop 0
v_cndmask_b32 v66, v73, v66, vcc
ds_read_u16 v92, v66 offset:0
ds_read_u16 v93, v66 offset:40
ds_read_u16 v94, v66 offset:80
ds_read_u16 v95, v66 offset:120
v_add_u32 v66, v71, v65
v_cndmask_b32 v66, v73, v66, vcc
v_cndmask_b32 v66, v73, v66, s[80:81]
ds_read_u16 v112, v66 offset:0
ds_read_u16 v113, v66 offset:40
ds_read_u16 v114, v66 offset:80
ds_read_u16 v115, v66 offset:120
s_waitcnt lgkmcnt(0)
v_lshl_or_b32 v71, v77, 16, v76
v_accvgpr_write_b32 a192, v71
v_lshl_or_b32 v71, v79, 16, v78
v_accvgpr_write_b32 a193, v71
v_lshl_or_b32 v71, v81, 16, v80
v_accvgpr_write_b32 a194, v71
v_lshl_or_b32 v71, v83, 16, v82
v_accvgpr_write_b32 a195, v71
v_lshl_or_b32 v71, v85, 16, v84
v_accvgpr_write_b32 a196, v71
v_lshl_or_b32 v71, v87, 16, v86
v_accvgpr_write_b32 a197, v71
v_lshl_or_b32 v71, v89, 16, v88
v_accvgpr_write_b32 a198, v71
v_lshl_or_b32 v71, v91, 16, v90
v_accvgpr_write_b32 a199, v71
v_lshl_or_b32 v71, v93, 16, v92
v_accvgpr_write_b32 a200, v71
v_lshl_or_b32 v71, v95, 16, v94
v_accvgpr_write_b32 a201, v71
v_accvgpr_write_b32 a202, 0
v_accvgpr_write_b32 a203, 0
v_lshl_or_b32 v71, v97, 16, v96
v_accvgpr_write_b32 a204, v71
v_lshl_or_b32 v71, v99, 16, v98
v_accvgpr_write_b32 a205, v71
v_lshl_or_b32 v71, v101, 16, v100
v_accvgpr_write_b32 a206, v71
v_lshl_or_b32 v71, v103, 16, v102
v_accvgpr_write_b32 a207, v71
v_lshl_or_b32 v71, v105, 16, v104
v_accvgpr_write_b32 a208, v71
v_lshl_or_b32 v71, v107, 16, v106
v_accvgpr_write_b32 a209, v71
v_lshl_or_b32 v71, v109, 16, v108
v_accvgpr_write_b32 a210, v71
v_lshl_or_b32 v71, v111, 16, v110
v_accvgpr_write_b32 a211, v71
v_lshl_or_b32 v71, v113, 16, v112
v_accvgpr_write_b32 a212, v71
v_lshl_or_b32 v71, v115, 16, v114
v_accvgpr_write_b32 a213, v71
v_accvgpr_write_b32 a214, 0
v_accvgpr_write_b32 a215, 0
s_waitcnt vmcnt(0)
v_lshlrev_b32 v190, 16, v190
v_lshlrev_b32 v191, 16, v191
v_lshlrev_b32 v192, 2, v0
v_cmp_gt_u32 vcc, 128, v0
s_nop 3
s_and_saveexec_b64 s[80:81], vcc
s_cbranch_execz Lb_13
ds_write_b32 v192, v190 offset:1024
ds_write_b32 v192, v191 offset:1536
Lb_13:
s_mov_b64 exec, s[80:81]
s_mov_b32 s88, s56
s_mov_b32 s89, s57
s_mov_b32 s90, s58
s_mov_b32 s79, s59
s_waitcnt lgkmcnt(0)
s_cmp_eq_u32 s40, 1
s_cbranch_scc0 Lep_14
v_mov_b32 v168, s84
v_mov_b32 v169, 16
v_cmp_eq_u32 vcc, 1, v1
v_mov_b32 v170, s85
s_nop 0
v_cndmask_b32 v168, v168, v170, vcc
v_mov_b32 v170, 16
v_cndmask_b32 v169, v169, v170, vcc
v_mov_b32 v171, 0xff
s_mov_b64 exec, 3
s_cmp_eq_u32 s53, 0
s_cselect_b32 s82, 0, 6000000
s_nop 1
Lp_15:
global_load_dword v170, v168, s[30:31] sc1
s_add_u32 s82, s82, 1
s_cmp_gt_u32 s82, 6000000
s_cbranch_scc1 Lpd_16_to
s_waitcnt vmcnt(0)
v_and_b32 v172, v171, v170
v_cmp_lt_u32 vcc, v172, v169
s_nop 4
s_cbranch_vccz Lpd_16
s_branch Lp_15
Lpd_16_to:
s_or_b32 s53, s53, 1
s_waitcnt vmcnt(0)
Lpd_16:
s_mov_b64 exec, -1
v_readfirstlane_b32 s56, v170
s_nop 3
s_bfe_u32 s57, s56, 0x80008
s_lshr_b32 s58, s56, 16
s_mul_i32 s57, s57, s57
s_lshl_b32 s58, s58, 4
s_cmp_eq_u32 s57, s58
s_cselect_b32 s56, 1, 0
s_cmp_eq_u32 s53, 0
s_cselect_b32 s56, s56, 0
v_mov_b32 v168, s56
v_mov_b32 v169, 9216
ds_write_b32 v169, v168
s_waitcnt lgkmcnt(0)
s_mov_b32 s56, s88
s_mov_b32 s57, s89
s_mov_b32 s58, s90
Lep_14:
s_cmp_lt_u32 s41, 12
s_cbranch_scc0 Lw1_17
s_add_u32 s60, s64, 0
s_mul_i32 s61, s60, 3072
s_lshl_b32 s66, s58, 10
s_add_u32 s61, s61, s66
s_mul_i32 s66, s42, 122880
s_add_u32 s61, s61, s66
s_add_u32 s61, s61, 8388608
ds_read_b64_tr_b16 v[216:217], v176 offset:3072
ds_read_b64_tr_b16 v[218:219], v176 offset:3328
s_waitcnt lgkmcnt(0)
v_dot2_f32_bf16 v195, v216, s52, v195
v_dot2_f32_bf16 v195, v217, s52, v195
v_dot2_f32_bf16 v195, v218, s52, v195
v_dot2_f32_bf16 v195, v219, s52, v195
buffer_store_dwordx4 v[216:219], v6, s[32:35], s61 offen sc1
s_add_u32 s60, s64, 4
s_mul_i32 s61, s60, 3072
s_lshl_b32 s66, s58, 10
s_add_u32 s61, s61, s66
s_mul_i32 s66, s42, 122880
s_add_u32 s61, s61, s66
s_add_u32 s61, s61, 8388608
ds_read_b64_tr_b16 v[212:213], v176 offset:4096
ds_read_b64_tr_b16 v[214:215], v176 offset:4352
s_waitcnt lgkmcnt(0)
v_dot2_f32_bf16 v195, v212, s52, v195
v_dot2_f32_bf16 v195, v213, s52, v195
v_dot2_f32_bf16 v195, v214, s52, v195
v_dot2_f32_bf16 v195, v215, s52, v195
buffer_store_dwordx4 v[212:215], v6, s[32:35], s61 offen sc1
s_cmp_lt_u32 s40, 2
s_nop 2
s_cbranch_scc0 Lw13_18
s_add_u32 s60, s64, 8
s_mul_i32 s61, s60, 3072
s_lshl_b32 s66, s58, 10
s_add_u32 s61, s61, s66
s_mul_i32 s66, s42, 122880
s_add_u32 s61, s61, s66
s_add_u32 s61, s61, 8388608
ds_read_b64_tr_b16 v[216:217], v176 offset:5120
ds_read_b64_tr_b16 v[218:219], v176 offset:5376
s_waitcnt lgkmcnt(0)
v_dot2_f32_bf16 v195, v216, s52, v195
v_dot2_f32_bf16 v195, v217, s52, v195
v_dot2_f32_bf16 v195, v218, s52, v195
v_dot2_f32_bf16 v195, v219, s52, v195
buffer_store_dwordx4 v[216:219], v6, s[32:35], s61 offen sc1
s_nop 3
Lw13_18:
v_lshlrev_b32 v220, 2, v0
ds_write_b32 v220, v195 offset:6784
s_nop 3
Lw1_17:
s_add_u32 s60, s65, 0
s_lshl_b32 s61, s60, 10
s_mul_i32 s66, s44, 245760
s_add_u32 s61, s61, s66
s_add_u32 s61, s61, 10485760
ds_read_b64_tr_b16 v[212:213], v177 offset:6144
ds_read_b64_tr_b16 v[214:215], v177 offset:6272
s_waitcnt lgkmcnt(0)
buffer_store_dwordx4 v[212:215], v6, s[32:35], s61 offen sc1
s_add_u32 s60, s65, 128
s_cmp_lt_u32 s60, 240
s_cbranch_scc0 Lw2p_19
s_lshl_b32 s61, s60, 10
s_mul_i32 s66, s44, 245760
s_add_u32 s61, s61, s66
s_add_u32 s61, s61, 10485760
ds_read_b64_tr_b16 v[216:217], v177 offset:7168
ds_read_b64_tr_b16 v[218:219], v177 offset:7296
s_waitcnt lgkmcnt(0)
buffer_store_dwordx4 v[216:219], v6, s[32:35], s61 offen sc1
s_nop 1
Lw2p_19:
s_cmp_lt_u32 s65, 100
s_cbranch_scc0 Lwop_20
s_lshl_b32 s61, s65, 10
s_mul_i32 s66, s44, 102400
s_add_u32 s61, s61, s66
s_add_u32 s61, s61, 7340032
ds_read_b64_tr_b16 v[212:213], v177 offset:8192
ds_read_b64_tr_b16 v[214:215], v177 offset:8320
s_waitcnt lgkmcnt(0)
buffer_store_dwordx4 v[212:215], v6, s[32:35], s61 offen sc1
s_nop 1
Lwop_20:
s_waitcnt lgkmcnt(0)
s_barrier
s_cmp_eq_u32 s40, 0
s_cbranch_scc0 Lcs_21
v_lshlrev_b32 v220, 2, v2
ds_read_b32 v222, v220 offset:5760
ds_read_b32 v223, v220 offset:5888
ds_read_b32 v224, v220 offset:6016
ds_read_b32 v225, v220 offset:6144
ds_read_b32 v226, v220 offset:6272
ds_read_b32 v227, v220 offset:6400
ds_read_b32 v228, v220 offset:6528
ds_read_b32 v229, v220 offset:6656
s_waitcnt lgkmcnt(0)
v_add_f32 v222, v222, v223
v_add_f32 v222, v222, v224
v_add_f32 v222, v222, v225
v_add_f32 v222, v222, v226
v_add_f32 v222, v222, v227
v_add_f32 v222, v222, v228
v_add_f32 v222, v222, v229
s_lshl_b32 s60, s42, 11
s_lshl_b32 s61, s89, 9
s_add_u32 s60, s60, s61
s_lshl_b32 s61, s88, 7
s_add_u32 s60, s60, s61
s_add_u32 s60, s60, 65536
v_cmp_gt_u32 vcc, 32, v1
v_mov_b32 v221, s51
s_nop 0
v_cndmask_b32 v220, v221, v220, vcc
buffer_store_dword v222, v220, s[32:35], s60 offen sc1
s_nop 3
Lcs_21:
s_cmp_lt_u32 s41, 12
s_cbranch_scc0 Lcs1o_22
s_cmp_eq_u32 s40, 0
s_cbranch_scc0 Lcs_23
v_lshlrev_b32 v220, 2, v2
ds_read_b32 v222, v220 offset:6784
ds_read_b32 v223, v220 offset:6912
ds_read_b32 v224, v220 offset:7040
ds_read_b32 v225, v220 offset:7168
ds_read_b32 v226, v220 offset:7296
ds_read_b32 v227, v220 offset:7424
ds_read_b32 v228, v220 offset:7552
ds_read_b32 v229, v220 offset:7680
s_waitcnt lgkmcnt(0)
v_add_f32 v222, v222, v223
v_add_f32 v222, v222, v224
v_add_f32 v222, v222, v225
v_add_f32 v222, v222, v226
v_add_f32 v222, v222, v227
v_add_f32 v222, v222, v228
v_add_f32 v222, v222, v229
s_lshl_b32 s60, s42, 11
s_lshl_b32 s61, s79, 9
s_add_u32 s60, s60, s61
s_lshl_b32 s61, s90, 7
s_add_u32 s60, s60, s61
s_add_u32 s60, s60, 131072
v_cmp_gt_u32 vcc, 32, v1
v_mov_b32 v221, s51
s_nop 0
v_cndmask_b32 v220, v221, v220, vcc
buffer_store_dword v222, v220, s[32:35], s60 offen sc1
s_nop 3
Lcs_23:
Lcs1o_22:
v_mov_b32 v169, 9216
ds_read_b32 v168, v169
s_waitcnt lgkmcnt(0)
v_readfirstlane_b32 s83, v168
s_nop 3
s_cmp_eq_u32 s83, 1
s_cselect_b32 s8, 0, s47
s_cselect_b32 s9, 0, 4194304
s_and_b32 s10, s83, s47
s_lshl_b32 s4, s40, 10
s_mul_i32 s64, s42, 153600
s_add_u32 s64, s64, s4
s_add_u32 s64, s64, 4194304
s_mul_i32 s65, s44, 102400
s_add_u32 s65, s65, s4
s_add_u32 s65, s65, 7340032
s_mul_i32 s66, s42, 122880
s_add_u32 s66, s66, s4
s_add_u32 s66, s66, 8388608
s_mul_i32 s67, s44, 245760
s_add_u32 s67, s67, s4
s_add_u32 s67, s67, 10485760
s_add_u32 m0, s4, 102400
s_add_u32 s5, s64, 0
buffer_load_dwordx4 v6, s[32:35], s5 offen sc1 lds
s_add_u32 m0, s4, 106496
s_add_u32 s5, s64, 4096
buffer_load_dwordx4 v6, s[32:35], s5 offen sc1 lds
s_add_u32 m0, s4, 110592
s_add_u32 s5, s64, 8192
buffer_load_dwordx4 v6, s[32:35], s5 offen sc1 lds
s_add_u32 m0, s4, 114688
s_add_u32 s5, s64, 12288
buffer_load_dwordx4 v6, s[32:35], s5 offen sc1 lds
s_add_u32 m0, s4, 118784
s_add_u32 s5, s64, 16384
buffer_load_dwordx4 v6, s[32:35], s5 offen sc1 lds
s_add_u32 m0, s4, 122880
s_add_u32 s5, s64, 20480
buffer_load_dwordx4 v6, s[32:35], s5 offen sc1 lds
s_add_u32 m0, s4, 126976
s_add_u32 s5, s64, 24576
buffer_load_dwordx4 v6, s[32:35], s5 offen sc1 lds
s_mov_b32 m0, 0x30000
s_mov_b32 s5, 28672
s_sub_u32 s6, s40, 0
s_cmp_lt_u32 s6, 2
s_cselect_b32 s5, 28672, s5
s_add_u32 s6, s4, 131072
s_sub_u32 s7, s40, 0
s_cmp_lt_u32 s7, 2
s_cselect_b32 m0, s6, m0
s_add_u32 s5, s5, s64
buffer_load_dwordx4 v6, s[32:35], s5 offen sc1 lds
L_layer:
s_lshl_b32 s59, s42, 11
s_add_u32 s59, s59, 65536
v_lshlrev_b32 v242, 2, v0
s_lshl_b32 s60, s47, 18
s_add_u32 s60, s60, 3145728
s_lshl_b32 s61, s8, 23
s_add_u32 s61, s61, 16777216
s_mul_i32 s62, s41, 163840
s_add_u32 s61, s61, s62
s_mul_i32 s62, s40, 40960
s_add_u32 s61, s61, s62
buffer_load_dwordx4 a[0:3], v6, s[32:35], s61 offen sc1
buffer_load_dwordx4 a[4:7], v6, s[32:35], s61 offen offset:1024 sc1
buffer_load_dwordx4 a[8:11], v6, s[32:35], s61 offen offset:2048 sc1
buffer_load_dwordx4 a[12:15], v6, s[32:35], s61 offen offset:3072 sc1
s_add_u32 s61, s61, 4096
buffer_load_dwordx4 a[16:19], v6, s[32:35], s61 offen sc1
buffer_load_dwordx4 a[20:23], v6, s[32:35], s61 offen offset:1024 sc1
buffer_load_dwordx4 a[24:27], v6, s[32:35], s61 offen offset:2048 sc1
buffer_load_dwordx4 a[28:31], v6, s[32:35], s61 offen offset:3072 sc1
s_add_u32 s61, s61, 4096
buffer_load_dwordx4 a[32:35], v6, s[32:35], s61 offen sc1
buffer_load_dwordx4 a[36:39], v6, s[32:35], s61 offen offset:1024 sc1
v_accvgpr_read_b32 v234, a236
v_add_u32 v56, 102400, v6
s_cmp_eq_u32 s47, 0
s_nop 3
s_cbranch_scc0 Lgat_24
s_add_u32 m0, s4, 133120
s_add_u32 s5, s64, 30720
buffer_load_dwordx4 v6, s[32:35], s5 offen sc1 lds
s_add_u32 m0, s4, 137216
s_add_u32 s5, s64, 34816
buffer_load_dwordx4 v6, s[32:35], s5 offen sc1 lds
s_add_u32 m0, s4, 141312
s_add_u32 s5, s64, 38912
buffer_load_dwordx4 v6, s[32:35], s5 offen sc1 lds
s_add_u32 m0, s4, 145408
s_add_u32 s5, s64, 43008
buffer_load_dwordx4 v6, s[32:35], s5 offen sc1 lds
s_add_u32 m0, s4, 149504
s_add_u32 s5, s64, 47104
buffer_load_dwordx4 v6, s[32:35], s5 offen sc1 lds
s_add_u32 m0, s4, 153600
s_add_u32 s5, s64, 51200
buffer_load_dwordx4 v6, s[32:35], s5 offen sc1 lds
s_add_u32 m0, s4, 157696
s_add_u32 s5, s64, 55296
buffer_load_dwordx4 v6, s[32:35], s5 offen sc1 lds
s_mov_b32 m0, 0x30000
s_mov_b32 s5, 59392
s_sub_u32 s6, s40, 0
s_cmp_lt_u32 s6, 2
s_cselect_b32 s5, 59392, s5
s_add_u32 s6, s4, 161792
s_sub_u32 s7, s40, 0
s_cmp_lt_u32 s7, 2
s_cselect_b32 m0, s6, m0
s_add_u32 s5, s5, s64
buffer_load_dwordx4 v6, s[32:35], s5 offen sc1 lds
Lgat_24:
s_waitcnt vmcnt(9)
s_barrier
s_or_b32 s91, s40, s47
s_cmp_eq_u32 s91, 0
s_cbranch_scc0 Larr2_25
s_mov_b64 exec, 1
v_mov_b32 v170, s85
global_atomic_add v170, v11, s[30:31] sc1
s_mov_b64 exec, -1
s_nop 2
Larr2_25:
ds_read_b128 v[128:131], v56 offset:0
ds_read_b128 v[132:135], v56 offset:1024
ds_read_b128 v[136:139], v56 offset:2048
ds_read_b128 v[140:143], v56 offset:3072
ds_read_b128 v[144:147], v56 offset:4096
ds_read_b128 v[148:151], v56 offset:5120
ds_read_b128 v[152:155], v56 offset:6144
ds_read_b128 v[156:159], v56 offset:7168
s_waitcnt lgkmcnt(7)
v_mfma_f32_32x32x16_bf16 v[64:79], v[128:131], a[0:3], 0
buffer_load_dwordx4 a[40:43], v6, s[32:35], s61 offen offset:2048 sc1
ds_read_b128 v[160:163], v56 offset:8192
s_waitcnt lgkmcnt(7)
v_mfma_f32_32x32x16_bf16 v[80:95], v[132:135], a[0:3], 0
ds_read_b128 v[164:167], v56 offset:9216
s_waitcnt lgkmcnt(7)
v_mfma_f32_32x32x16_bf16 v[96:111], v[136:139], a[0:3], 0
s_add_u32 m0, s4, 10240
s_add_u32 s5, s64, 61440
buffer_load_dwordx4 v6, s[32:35], s5 offen sc1 lds
s_waitcnt vmcnt(10)
ds_read_b128 v[128:131], v56 offset:10240
s_waitcnt lgkmcnt(7)
v_mfma_f32_32x32x16_bf16 v[64:79], v[140:143], a[4:7], v[64:79]
buffer_load_dwordx4 a[44:47], v6, s[32:35], s61 offen offset:3072 sc1
ds_read_b128 v[132:135], v56 offset:11264
s_waitcnt lgkmcnt(7)
v_mfma_f32_32x32x16_bf16 v[80:95], v[144:147], a[4:7], v[80:95]
ds_read_b128 v[136:139], v56 offset:12288
s_waitcnt lgkmcnt(7)
v_mfma_f32_32x32x16_bf16 v[96:111], v[148:151], a[4:7], v[96:111]
s_add_u32 m0, s4, 14336
s_add_u32 s5, s64, 65536
buffer_load_dwordx4 v6, s[32:35], s5 offen sc1 lds
s_waitcnt vmcnt(11)
ds_read_b128 v[140:143], v56 offset:13312
s_waitcnt lgkmcnt(7)
v_mfma_f32_32x32x16_bf16 v[64:79], v[152:155], a[8:11], v[64:79]
s_add_u32 s61, s61, 4096
buffer_load_dwordx4 a[48:51], v6, s[32:35], s61 offen sc1
ds_read_b128 v[144:147], v56 offset:14336
s_waitcnt lgkmcnt(7)
v_mfma_f32_32x32x16_bf16 v[80:95], v[156:159], a[8:11], v[80:95]
ds_read_b128 v[148:151], v56 offset:15360
s_waitcnt lgkmcnt(7)
v_mfma_f32_32x32x16_bf16 v[96:111], v[160:163], a[8:11], v[96:111]
s_add_u32 m0, s4, 18432
s_add_u32 s5, s64, 69632
buffer_load_dwordx4 v6, s[32:35], s5 offen sc1 lds
s_waitcnt vmcnt(12)
ds_read_b128 v[152:155], v56 offset:16384
s_waitcnt lgkmcnt(7)
v_mfma_f32_32x32x16_bf16 v[64:79], v[164:167], a[12:15], v[64:79]
buffer_load_dwordx4 a[52:55], v6, s[32:35], s61 offen offset:1024 sc1
ds_read_b128 v[156:159], v56 offset:17408
s_waitcnt lgkmcnt(7)
v_mfma_f32_32x32x16_bf16 v[80:95], v[128:131], a[12:15], v[80:95]
ds_read_b128 v[160:163], v56 offset:18432
s_waitcnt lgkmcnt(7)
v_mfma_f32_32x32x16_bf16 v[96:111], v[132:135], a[12:15], v[96:111]
s_add_u32 m0, s4, 22528
s_add_u32 s5, s64, 73728
buffer_load_dwordx4 v6, s[32:35], s5 offen sc1 lds
s_waitcnt vmcnt(13)
ds_read_b128 v[164:167], v56 offset:19456
s_waitcnt lgkmcnt(7)
v_mfma_f32_32x32x16_bf16 v[64:79], v[136:139], a[16:19], v[64:79]
buffer_load_dwordx4 a[56:59], v6, s[32:35], s61 offen offset:2048 sc1
ds_read_b128 v[128:131], v56 offset:20480
s_waitcnt lgkmcnt(7)
v_mfma_f32_32x32x16_bf16 v[80:95], v[140:143], a[16:19], v[80:95]
ds_read_b128 v[132:135], v56 offset:21504
s_waitcnt lgkmcnt(7)
v_mfma_f32_32x32x16_bf16 v[96:111], v[144:147], a[16:19], v[96:111]
s_add_u32 m0, s4, 26624
s_add_u32 s5, s64, 77824
buffer_load_dwordx4 v6, s[32:35], s5 offen sc1 lds
s_waitcnt vmcnt(14)
ds_read_b128 v[136:139], v56 offset:22528
s_waitcnt lgkmcnt(7)
v_mfma_f32_32x32x16_bf16 v[64:79], v[148:151], a[20:23], v[64:79]
buffer_load_dwordx4 a[60:63], v6, s[32:35], s61 offen offset:3072 sc1
ds_read_b128 v[140:143], v56 offset:23552
s_waitcnt lgkmcnt(7)
v_mfma_f32_32x32x16_bf16 v[80:95], v[152:155], a[20:23], v[80:95]
ds_read_b128 v[144:147], v56 offset:24576
s_waitcnt lgkmcnt(7)
v_mfma_f32_32x32x16_bf16 v[96:111], v[156:159], a[20:23], v[96:111]
s_add_u32 m0, s4, 30720
s_add_u32 s5, s64, 81920
buffer_load_dwordx4 v6, s[32:35], s5 offen sc1 lds
s_waitcnt vmcnt(15)
ds_read_b128 v[148:151], v56 offset:25600
s_waitcnt lgkmcnt(7)
v_mfma_f32_32x32x16_bf16 v[64:79], v[160:163], a[24:27], v[64:79]
s_add_u32 s61, s61, 4096
buffer_load_dwordx4 a[64:67], v6, s[32:35], s61 offen sc1
ds_read_b128 v[152:155], v56 offset:26624
s_waitcnt lgkmcnt(7)
v_mfma_f32_32x32x16_bf16 v[80:95], v[164:167], a[24:27], v[80:95]
ds_read_b128 v[156:159], v56 offset:27648
s_waitcnt lgkmcnt(7)
v_mfma_f32_32x32x16_bf16 v[96:111], v[128:131], a[24:27], v[96:111]
s_add_u32 m0, s4, 34816
s_add_u32 s5, s64, 86016
buffer_load_dwordx4 v6, s[32:35], s5 offen sc1 lds
s_waitcnt vmcnt(16)
ds_read_b128 v[160:163], v56 offset:28672
s_waitcnt lgkmcnt(7)
v_mfma_f32_32x32x16_bf16 v[64:79], v[132:135], a[28:31], v[64:79]
buffer_load_dwordx4 a[68:71], v6, s[32:35], s61 offen offset:1024 sc1
ds_read_b128 v[164:167], v56 offset:29696
s_waitcnt lgkmcnt(7)
v_mfma_f32_32x32x16_bf16 v[80:95], v[136:139], a[28:31], v[80:95]
s_waitcnt vmcnt(14)
s_barrier
ds_read_b128 v[128:131], v56 offset:30720
s_waitcnt lgkmcnt(7)
v_mfma_f32_32x32x16_bf16 v[96:111], v[140:143], a[28:31], v[96:111]
s_mov_b32 m0, 0x30000
s_mov_b32 s5, 90112
s_sub_u32 s6, s40, 0
s_cmp_lt_u32 s6, 2
s_cselect_b32 s5, 90112, s5
s_add_u32 s6, s4, 38912
s_sub_u32 s7, s40, 0
s_cmp_lt_u32 s7, 2
s_cselect_b32 m0, s6, m0
s_add_u32 s5, s5, s64
buffer_load_dwordx4 v6, s[32:35], s5 offen sc1 lds
ds_read_b128 v[132:135], v56 offset:31744
s_waitcnt lgkmcnt(7)
v_mfma_f32_32x32x16_bf16 v[64:79], v[144:147], a[32:35], v[64:79]
buffer_load_dwordx4 a[72:75], v6, s[32:35], s61 offen offset:2048 sc1
ds_read_b128 v[136:139], v56 offset:32768
s_waitcnt lgkmcnt(7)
v_mfma_f32_32x32x16_bf16 v[80:95], v[148:151], a[32:35], v[80:95]
ds_read_b128 v[140:143], v56 offset:33792
s_waitcnt lgkmcnt(7)
v_mfma_f32_32x32x16_bf16 v[96:111], v[152:155], a[32:35], v[96:111]
s_add_u32 m0, s4, 40960
s_add_u32 s5, s64, 92160
buffer_load_dwordx4 v6, s[32:35], s5 offen sc1 lds
ds_read_b128 v[144:147], v56 offset:34816
s_waitcnt lgkmcnt(7)
v_mfma_f32_32x32x16_bf16 v[64:79], v[156:159], a[36:39], v[64:79]
buffer_load_dwordx4 a[76:79], v6, s[32:35], s61 offen offset:3072 sc1
ds_read_b128 v[148:151], v56 offset:35840
s_waitcnt lgkmcnt(7)
v_mfma_f32_32x32x16_bf16 v[80:95], v[160:163], a[36:39], v[80:95]
ds_read_b128 v[152:155], v56 offset:36864
s_waitcnt lgkmcnt(7)
v_mfma_f32_32x32x16_bf16 v[96:111], v[164:167], a[36:39], v[96:111]
s_add_u32 m0, s4, 45056
s_add_u32 s5, s64, 96256
buffer_load_dwordx4 v6, s[32:35], s5 offen sc1 lds
ds_read_b128 v[156:159], v56 offset:37888
s_waitcnt lgkmcnt(7)
v_mfma_f32_32x32x16_bf16 v[64:79], v[128:131], a[40:43], v[64:79]
s_add_u32 s61, s61, 4096
buffer_load_dwordx4 a[80:83], v6, s[32:35], s61 offen sc1
ds_read_b128 v[160:163], v56 offset:38912
s_waitcnt lgkmcnt(7)
v_mfma_f32_32x32x16_bf16 v[80:95], v[132:135], a[40:43], v[80:95]
ds_read_b128 v[164:167], v56 offset:39936
s_waitcnt lgkmcnt(7)
v_mfma_f32_32x32x16_bf16 v[96:111], v[136:139], a[40:43], v[96:111]
s_add_u32 m0, s4, 49152
s_add_u32 s5, s64, 100352
buffer_load_dwordx4 v6, s[32:35], s5 offen sc1 lds
s_waitcnt vmcnt(19)
ds_read_b128 v[128:131], v56 offset:40960
s_waitcnt lgkmcnt(7)
v_mfma_f32_32x32x16_bf16 v[64:79], v[140:143], a[44:47], v[64:79]
buffer_load_dwordx4 a[84:87], v6, s[32:35], s61 offen offset:1024 sc1
ds_read_b128 v[132:135], v56 offset:41984
s_waitcnt lgkmcnt(7)
v_mfma_f32_32x32x16_bf16 v[80:95], v[144:147], a[44:47], v[80:95]
global_load_dword v235, v234, s[30:31] sc1
ds_read_b128 v[136:139], v56 offset:43008
s_waitcnt lgkmcnt(7)
v_mfma_f32_32x32x16_bf16 v[96:111], v[148:151], a[44:47], v[96:111]
s_add_u32 m0, s4, 53248
s_add_u32 s5, s64, 104448
buffer_load_dwordx4 v6, s[32:35], s5 offen sc1 lds
s_waitcnt vmcnt(20)
ds_read_b128 v[140:143], v56 offset:44032
s_waitcnt lgkmcnt(7)
v_mfma_f32_32x32x16_bf16 v[64:79], v[152:155], a[48:51], v[64:79]
buffer_load_dwordx4 a[88:91], v6, s[32:35], s61 offen offset:2048 sc1
ds_read_b128 v[144:147], v56 offset:45056
s_waitcnt lgkmcnt(7)
v_mfma_f32_32x32x16_bf16 v[80:95], v[156:159], a[48:51], v[80:95]
ds_read_b128 v[148:151], v56 offset:46080
s_waitcnt lgkmcnt(7)
v_mfma_f32_32x32x16_bf16 v[96:111], v[160:163], a[48:51], v[96:111]
s_add_u32 m0, s4, 57344
s_add_u32 s5, s64, 108544
buffer_load_dwordx4 v6, s[32:35], s5 offen sc1 lds
s_waitcnt vmcnt(20)
ds_read_b128 v[152:155], v56 offset:47104
s_waitcnt lgkmcnt(7)
v_mfma_f32_32x32x16_bf16 v[64:79], v[164:167], a[52:55], v[64:79]
buffer_load_dwordx4 a[92:95], v6, s[32:35], s61 offen offset:3072 sc1
ds_read_b128 v[156:159], v56 offset:48128
s_waitcnt lgkmcnt(7)
v_mfma_f32_32x32x16_bf16 v[80:95], v[128:131], a[52:55], v[80:95]
ds_read_b128 v[160:163], v56 offset:49152
s_waitcnt lgkmcnt(7)
v_mfma_f32_32x32x16_bf16 v[96:111], v[132:135], a[52:55], v[96:111]
s_add_u32 m0, s4, 61440
s_add_u32 s5, s64, 112640
buffer_load_dwordx4 v6, s[32:35], s5 offen sc1 lds
s_waitcnt vmcnt(20)
ds_read_b128 v[164:167], v56 offset:50176
s_waitcnt lgkmcnt(7)
v_mfma_f32_32x32x16_bf16 v[64:79], v[136:139], a[56:59], v[64:79]
s_add_u32 s61, s61, 4096
buffer_load_dwordx4 a[96:99], v6, s[32:35], s61 offen sc1
ds_read_b128 v[128:131], v56 offset:51200
s_waitcnt lgkmcnt(7)
v_mfma_f32_32x32x16_bf16 v[80:95], v[140:143], a[56:59], v[80:95]
ds_read_b128 v[132:135], v56 offset:52224
s_waitcnt lgkmcnt(7)
v_mfma_f32_32x32x16_bf16 v[96:111], v[144:147], a[56:59], v[96:111]
s_add_u32 m0, s4, 65536
s_add_u32 s5, s64, 116736
buffer_load_dwordx4 v6, s[32:35], s5 offen sc1 lds
s_waitcnt vmcnt(20)
ds_read_b128 v[136:139], v56 offset:53248
s_waitcnt lgkmcnt(7)
v_mfma_f32_32x32x16_bf16 v[64:79], v[148:151], a[60:63], v[64:79]
buffer_load_dwordx4 a[100:103], v6, s[32:35], s61 offen offset:1024 sc1
ds_read_b128 v[140:143], v56 offset:54272
s_waitcnt lgkmcnt(7)
v_mfma_f32_32x32x16_bf16 v[80:95], v[152:155], a[60:63], v[80:95]
ds_read_b128 v[144:147], v56 offset:55296
s_waitcnt lgkmcnt(7)
v_mfma_f32_32x32x16_bf16 v[96:111], v[156:159], a[60:63], v[96:111]
s_mov_b32 m0, 0x30000
s_mov_b32 s5, 120832
s_sub_u32 s6, s40, 0
s_cmp_lt_u32 s6, 2
s_cselect_b32 s5, 120832, s5
s_add_u32 s6, s4, 69632
s_sub_u32 s7, s40, 0
s_cmp_lt_u32 s7, 2
s_cselect_b32 m0, s6, m0
s_add_u32 s5, s5, s64
buffer_load_dwordx4 v6, s[32:35], s5 offen sc1 lds
s_waitcnt vmcnt(20)
ds_read_b128 v[148:151], v56 offset:56320
s_waitcnt lgkmcnt(7)
v_mfma_f32_32x32x16_bf16 v[64:79], v[160:163], a[64:67], v[64:79]
buffer_load_dwordx4 a[104:107], v6, s[32:35], s61 offen offset:2048 sc1
ds_read_b128 v[152:155], v56 offset:57344
s_waitcnt lgkmcnt(7)
v_mfma_f32_32x32x16_bf16 v[80:95], v[164:167], a[64:67], v[80:95]
ds_read_b128 v[156:159], v56 offset:58368
s_waitcnt lgkmcnt(7)
v_mfma_f32_32x32x16_bf16 v[96:111], v[128:131], a[64:67], v[96:111]
s_add_u32 m0, s4, 71680
s_add_u32 s5, s64, 122880
buffer_load_dwordx4 v6, s[32:35], s5 offen sc1 lds
s_waitcnt vmcnt(20)
ds_read_b128 v[160:163], v56 offset:59392
s_waitcnt lgkmcnt(7)
v_mfma_f32_32x32x16_bf16 v[64:79], v[132:135], a[68:71], v[64:79]
buffer_load_dwordx4 a[108:111], v6, s[32:35], s61 offen offset:3072 sc1
ds_read_b128 v[164:167], v56 offset:60416
s_waitcnt lgkmcnt(7)
v_mfma_f32_32x32x16_bf16 v[80:95], v[136:139], a[68:71], v[80:95]
s_waitcnt vmcnt(12)
s_cmp_eq_u32 s40, 0
s_nop 9
s_cbranch_scc0 Lchk_26
s_mov_b64 exec, 3
v_cmp_gt_u32 vcc, 32, v235
s_mov_b64 exec, -1
s_nop 3
s_cbranch_vccz Lchk_27
v_mov_b32 v168, s85
v_mov_b32 v169, 32
v_cmp_eq_u32 vcc, 1, v1
v_mov_b32 v170, s86
s_nop 0
v_cndmask_b32 v168, v168, v170, vcc
v_mov_b32 v170, 32
v_cndmask_b32 v169, v169, v170, vcc
v_mov_b32 v171, 0xff
s_mov_b64 exec, 3
s_cmp_eq_u32 s53, 0
s_cselect_b32 s82, 0, 6000000
s_nop 1
Lp_28:
global_load_dword v170, v168, s[30:31] sc1
s_add_u32 s82, s82, 1
s_cmp_gt_u32 s82, 6000000
s_cbranch_scc1 Lpd_29_to
s_waitcnt vmcnt(0)
v_and_b32 v172, v171, v170
v_cmp_lt_u32 vcc, v172, v169
s_nop 4
s_cbranch_vccz Lpd_29
s_branch Lp_28
Lpd_29_to:
s_or_b32 s53, s53, 4
s_waitcnt vmcnt(0)
Lpd_29:
s_mov_b64 exec, -1
Lchk_27:
Lchk_26:
s_barrier
v_add_u32 v56, -92160, v56
ds_read_b128 v[128:131], v56 offset:0
s_waitcnt lgkmcnt(7)
v_mfma_f32_32x32x16_bf16 v[96:111], v[140:143], a[68:71], v[96:111]
s_add_u32 m0, s4, 75776
s_add_u32 s5, s64, 126976
buffer_load_dwordx4 v6, s[32:35], s5 offen sc1 lds
ds_read_b128 v[132:135], v56 offset:1024
s_waitcnt lgkmcnt(7)
v_mfma_f32_32x32x16_bf16 v[64:79], v[144:147], a[72:75], v[64:79]
s_add_u32 s61, s61, 4096
buffer_load_dwordx4 a[112:115], v6, s[32:35], s61 offen sc1
ds_read_b128 v[136:139], v56 offset:2048
s_waitcnt lgkmcnt(7)
v_mfma_f32_32x32x16_bf16 v[80:95], v[148:151], a[72:75], v[80:95]
ds_read_b128 v[140:143], v56 offset:3072
s_waitcnt lgkmcnt(7)
v_mfma_f32_32x32x16_bf16 v[96:111], v[152:155], a[72:75], v[96:111]
s_add_u32 m0, s4, 79872
s_add_u32 s5, s64, 131072
buffer_load_dwordx4 v6, s[32:35], s5 offen sc1 lds
ds_read_b128 v[144:147], v56 offset:4096
s_waitcnt lgkmcnt(7)
v_mfma_f32_32x32x16_bf16 v[64:79], v[156:159], a[76:79], v[64:79]
buffer_load_dwordx4 a[116:119], v6, s[32:35], s61 offen offset:1024 sc1
ds_read_b128 v[148:151], v56 offset:5120
s_waitcnt lgkmcnt(7)
v_mfma_f32_32x32x16_bf16 v[80:95], v[160:163], a[76:79], v[80:95]
ds_read_b128 v[152:155], v56 offset:6144
s_waitcnt lgkmcnt(7)
v_mfma_f32_32x32x16_bf16 v[96:111], v[164:167], a[76:79], v[96:111]
s_add_u32 m0, s4, 83968
s_add_u32 s5, s64, 135168
buffer_load_dwordx4 v6, s[32:35], s5 offen sc1 lds
ds_read_b128 v[156:159], v56 offset:7168
s_waitcnt lgkmcnt(7)
v_mfma_f32_32x32x16_bf16 v[64:79], v[128:131], a[80:83], v[64:79]
buffer_load_dwordx4 a[120:123], v6, s[32:35], s61 offen offset:2048 sc1
ds_read_b128 v[160:163], v56 offset:8192
s_waitcnt lgkmcnt(7)
v_mfma_f32_32x32x16_bf16 v[80:95], v[132:135], a[80:83], v[80:95]
v_accvgpr_read_b32 v252, a235
s_mov_b32 s56, s60
buffer_load_dwordx2 v[244:245], v252, s[32:35], s56 offen sc1
s_add_u32 s56, s56, 16384
buffer_load_dwordx2 v[246:247], v252, s[32:35], s56 offen sc1
s_add_u32 s56, s56, 16384
buffer_load_dwordx2 v[248:249], v252, s[32:35], s56 offen sc1
s_add_u32 s56, s56, 16384
buffer_load_dwordx2 v[250:251], v252, s[32:35], s56 offen sc1
buffer_load_dword v238, v242, s[32:35], s59 offen offset:0 sc1
buffer_load_dword v239, v242, s[32:35], s59 offen offset:512 sc1
buffer_load_dword v240, v242, s[32:35], s59 offen offset:1024 sc1
buffer_load_dword v241, v242, s[32:35], s59 offen offset:1536 sc1
ds_read_b128 v[164:167], v56 offset:9216
s_waitcnt lgkmcnt(7)
v_mfma_f32_32x32x16_bf16 v[96:111], v[136:139], a[80:83], v[96:111]
s_add_u32 m0, s4, 88064
s_add_u32 s5, s64, 139264
buffer_load_dwordx4 v6, s[32:35], s5 offen sc1 lds
s_barrier
ds_read_b128 v[128:131], v56 offset:10240
s_waitcnt lgkmcnt(7)
v_mfma_f32_32x32x16_bf16 v[64:79], v[140:143], a[84:87], v[64:79]
buffer_load_dwordx4 a[124:127], v6, s[32:35], s61 offen offset:3072 sc1
ds_read_b128 v[132:135], v56 offset:11264
s_waitcnt lgkmcnt(7)
v_mfma_f32_32x32x16_bf16 v[80:95], v[144:147], a[84:87], v[80:95]
ds_read_b128 v[136:139], v56 offset:12288
s_waitcnt lgkmcnt(7)
v_mfma_f32_32x32x16_bf16 v[96:111], v[148:151], a[84:87], v[96:111]
s_add_u32 m0, s4, 92160
s_add_u32 s5, s64, 143360
buffer_load_dwordx4 v6, s[32:35], s5 offen sc1 lds
s_waitcnt vmcnt(27)
ds_read_b128 v[140:143], v56 offset:13312
s_waitcnt lgkmcnt(7)
v_mfma_f32_32x32x16_bf16 v[64:79], v[152:155], a[88:91], v[64:79]
s_add_u32 s61, s61, 4096
buffer_load_dwordx4 a[128:131], v6, s[32:35], s61 offen sc1
ds_read_b128 v[144:147], v56 offset:14336
s_waitcnt lgkmcnt(7)
v_mfma_f32_32x32x16_bf16 v[80:95], v[156:159], a[88:91], v[80:95]
ds_read_b128 v[148:151], v56 offset:15360
s_waitcnt lgkmcnt(7)
v_mfma_f32_32x32x16_bf16 v[96:111], v[160:163], a[88:91], v[96:111]
s_add_u32 m0, s4, 96256
s_add_u32 s5, s64, 147456
buffer_load_dwordx4 v6, s[32:35], s5 offen sc1 lds
s_waitcnt vmcnt(27)
ds_read_b128 v[152:155], v56 offset:16384
s_waitcnt lgkmcnt(7)
v_mfma_f32_32x32x16_bf16 v[64:79], v[164:167], a[92:95], v[64:79]
buffer_load_dwordx4 a[132:135], v6, s[32:35], s61 offen offset:1024 sc1
ds_read_b128 v[156:159], v56 offset:17408
s_waitcnt lgkmcnt(7)
v_mfma_f32_32x32x16_bf16 v[80:95], v[128:131], a[92:95], v[80:95]
ds_read_b128 v[160:163], v56 offset:18432
s_waitcnt lgkmcnt(7)
v_mfma_f32_32x32x16_bf16 v[96:111], v[132:135], a[92:95], v[96:111]
s_mov_b32 m0, 0x30000
s_mov_b32 s5, 151552
s_sub_u32 s6, s40, 0
s_cmp_lt_u32 s6, 2
s_cselect_b32 s5, 151552, s5
s_add_u32 s6, s4, 100352
s_sub_u32 s7, s40, 0
s_cmp_lt_u32 s7, 2
s_cselect_b32 m0, s6, m0
s_add_u32 s5, s5, s64
buffer_load_dwordx4 v6, s[32:35], s5 offen sc1 lds
s_waitcnt vmcnt(27)
ds_read_b128 v[164:167], v56 offset:19456
s_waitcnt lgkmcnt(7)
v_mfma_f32_32x32x16_bf16 v[64:79], v[136:139], a[96:99], v[64:79]
buffer_load_dwordx4 a[136:139], v6, s[32:35], s61 offen offset:2048 sc1
ds_read_b128 v[128:131], v56 offset:20480
s_waitcnt lgkmcnt(7)
v_mfma_f32_32x32x16_bf16 v[80:95], v[140:143], a[96:99], v[80:95]
ds_read_b128 v[132:135], v56 offset:21504
s_waitcnt lgkmcnt(7)
v_mfma_f32_32x32x16_bf16 v[96:111], v[144:147], a[96:99], v[96:111]
s_waitcnt vmcnt(26)
ds_read_b128 v[136:139], v56 offset:22528
s_waitcnt lgkmcnt(7)
v_mfma_f32_32x32x16_bf16 v[64:79], v[148:151], a[100:103], v[64:79]
buffer_load_dwordx4 a[140:143], v6, s[32:35], s61 offen offset:3072 sc1
ds_read_b128 v[140:143], v56 offset:23552
s_waitcnt lgkmcnt(7)
v_mfma_f32_32x32x16_bf16 v[80:95], v[152:155], a[100:103], v[80:95]
ds_read_b128 v[144:147], v56 offset:24576
s_waitcnt lgkmcnt(7)
v_mfma_f32_32x32x16_bf16 v[96:111], v[156:159], a[100:103], v[96:111]
s_waitcnt vmcnt(25)
ds_read_b128 v[148:151], v56 offset:25600
s_waitcnt lgkmcnt(7)
v_mfma_f32_32x32x16_bf16 v[64:79], v[160:163], a[104:107], v[64:79]
s_add_u32 s61, s61, 4096
buffer_load_dwordx4 a[144:147], v6, s[32:35], s61 offen sc1
ds_read_b128 v[152:155], v56 offset:26624
s_waitcnt lgkmcnt(7)
v_mfma_f32_32x32x16_bf16 v[80:95], v[164:167], a[104:107], v[80:95]
ds_read_b128 v[156:159], v56 offset:27648
s_waitcnt lgkmcnt(7)
v_mfma_f32_32x32x16_bf16 v[96:111], v[128:131], a[104:107], v[96:111]
s_waitcnt vmcnt(24)
ds_read_b128 v[160:163], v56 offset:28672
s_waitcnt lgkmcnt(7)
v_mfma_f32_32x32x16_bf16 v[64:79], v[132:135], a[108:111], v[64:79]
buffer_load_dwordx4 a[148:151], v6, s[32:35], s61 offen offset:1024 sc1
ds_read_b128 v[164:167], v56 offset:29696
s_waitcnt lgkmcnt(7)
v_mfma_f32_32x32x16_bf16 v[80:95], v[136:139], a[108:111], v[80:95]
s_barrier
ds_read_b128 v[128:131], v56 offset:30720
s_waitcnt lgkmcnt(7)
v_mfma_f32_32x32x16_bf16 v[96:111], v[140:143], a[108:111], v[96:111]
s_waitcnt vmcnt(23)
ds_read_b128 v[132:135], v56 offset:31744
s_waitcnt lgkmcnt(7)
v_mfma_f32_32x32x16_bf16 v[64:79], v[144:147], a[112:115], v[64:79]
buffer_load_dwordx4 a[152:155], v6, s[32:35], s61 offen offset:2048 sc1
ds_read_b128 v[136:139], v56 offset:32768
s_waitcnt lgkmcnt(7)
v_mfma_f32_32x32x16_bf16 v[80:95], v[148:151], a[112:115], v[80:95]
ds_read_b128 v[140:143], v56 offset:33792
s_waitcnt lgkmcnt(7)
v_mfma_f32_32x32x16_bf16 v[96:111], v[152:155], a[112:115], v[96:111]
s_waitcnt vmcnt(22)
ds_read_b128 v[144:147], v56 offset:34816
s_waitcnt lgkmcnt(7)
v_mfma_f32_32x32x16_bf16 v[64:79], v[156:159], a[116:119], v[64:79]
buffer_load_dwordx4 a[156:159], v6, s[32:35], s61 offen offset:3072 sc1
ds_read_b128 v[148:151], v56 offset:35840
s_waitcnt lgkmcnt(7)
v_mfma_f32_32x32x16_bf16 v[80:95], v[160:163], a[116:119], v[80:95]
ds_read_b128 v[152:155], v56 offset:36864
s_waitcnt lgkmcnt(7)
v_mfma_f32_32x32x16_bf16 v[96:111], v[164:167], a[116:119], v[96:111]
s_waitcnt vmcnt(21)
ds_read_b128 v[156:159], v56 offset:37888
s_waitcnt lgkmcnt(7)
v_mfma_f32_32x32x16_bf16 v[64:79], v[128:131], a[120:123], v[64:79]
ds_read_b128 v[160:163], v56 offset:38912
s_waitcnt lgkmcnt(7)
v_mfma_f32_32x32x16_bf16 v[80:95], v[132:135], a[120:123], v[80:95]
ds_read_b128 v[164:167], v56 offset:39936
s_waitcnt lgkmcnt(7)
v_mfma_f32_32x32x16_bf16 v[96:111], v[136:139], a[120:123], v[96:111]
s_waitcnt vmcnt(11)
ds_read_b128 v[128:131], v56 offset:40960
s_waitcnt lgkmcnt(7)
v_mfma_f32_32x32x16_bf16 v[64:79], v[140:143], a[124:127], v[64:79]
ds_read_b128 v[132:135], v56 offset:41984
s_waitcnt lgkmcnt(7)
v_mfma_f32_32x32x16_bf16 v[80:95], v[144:147], a[124:127], v[80:95]
ds_read_b128 v[136:139], v56 offset:43008
s_waitcnt lgkmcnt(7)
v_mfma_f32_32x32x16_bf16 v[96:111], v[148:151], a[124:127], v[96:111]
s_waitcnt vmcnt(9)
ds_read_b128 v[140:143], v56 offset:44032
s_waitcnt lgkmcnt(7)
v_mfma_f32_32x32x16_bf16 v[64:79], v[152:155], a[128:131], v[64:79]
ds_read_b128 v[144:147], v56 offset:45056
s_waitcnt lgkmcnt(7)
v_mfma_f32_32x32x16_bf16 v[80:95], v[156:159], a[128:131], v[80:95]
ds_read_b128 v[148:151], v56 offset:46080
s_waitcnt lgkmcnt(7)
v_mfma_f32_32x32x16_bf16 v[96:111], v[160:163], a[128:131], v[96:111]
s_waitcnt vmcnt(7)
ds_read_b128 v[152:155], v56 offset:47104
s_waitcnt lgkmcnt(7)
v_mfma_f32_32x32x16_bf16 v[64:79], v[164:167], a[132:135], v[64:79]
ds_read_b128 v[156:159], v56 offset:48128
s_waitcnt lgkmcnt(7)
v_mfma_f32_32x32x16_bf16 v[80:95], v[128:131], a[132:135], v[80:95]
v_add_f32 v238, v238, v239
v_add_f32 v240, v240, v241
ds_read_b128 v[160:163], v56 offset:49152
s_waitcnt lgkmcnt(7)
v_mfma_f32_32x32x16_bf16 v[96:111], v[132:135], a[132:135], v[96:111]
v_accvgpr_read_b32 v242, a237
v_add_f32 v238, v238, v240
ds_write_b32 v242, v238 offset:0
s_waitcnt vmcnt(5)
ds_read_b128 v[164:167], v56 offset:50176
s_waitcnt lgkmcnt(8)
v_mfma_f32_32x32x16_bf16 v[64:79], v[136:139], a[136:139], v[64:79]
ds_read_b128 v[128:131], v56 offset:51200
s_waitcnt lgkmcnt(8)
v_mfma_f32_32x32x16_bf16 v[80:95], v[140:143], a[136:139], v[80:95]
v_pk_add_f32 v[244:245], v[244:245], v[246:247]
v_pk_add_f32 v[248:249], v[248:249], v[250:251]
v_pk_add_f32 v[244:245], v[244:245], v[248:249]
ds_read_b128 v[132:135], v56 offset:52224
s_waitcnt lgkmcnt(8)
v_mfma_f32_32x32x16_bf16 v[96:111], v[144:147], a[136:139], v[96:111]
v_mov_b32 v252, v244
v_mov_b32 v253, v245
s_nop 0
v_permlane32_swap_b32 v244, v252
s_waitcnt vmcnt(4)
ds_read_b128 v[136:139], v56 offset:53248
s_waitcnt lgkmcnt(8)
v_mfma_f32_32x32x16_bf16 v[64:79], v[148:151], a[140:143], v[64:79]
ds_read_b128 v[140:143], v56 offset:54272
s_waitcnt lgkmcnt(8)
v_mfma_f32_32x32x16_bf16 v[80:95], v[152:155], a[140:143], v[80:95]
v_permlane32_swap_b32 v245, v253
v_add_f32 v244, v244, v252
v_add_f32 v245, v245, v253
ds_read_b128 v[144:147], v56 offset:55296
s_waitcnt lgkmcnt(8)
v_mfma_f32_32x32x16_bf16 v[96:111], v[156:159], a[140:143], v[96:111]
s_mov_b32 s91, 986500301
v_mul_f32 v244, s91, v244
v_mul_f32 v245, s91, v245
s_waitcnt vmcnt(3)
ds_read_b128 v[148:151], v56 offset:56320
s_waitcnt lgkmcnt(8)
v_mfma_f32_32x32x16_bf16 v[64:79], v[160:163], a[144:147], v[64:79]
ds_read_b128 v[152:155], v56 offset:57344
s_waitcnt lgkmcnt(7)
v_mfma_f32_32x32x16_bf16 v[80:95], v[164:167], a[144:147], v[80:95]
v_fma_f32 v245, -v244, v244, v245
v_max_f32 v245, 0, v245
v_sub_f32 v12, 0, v244
ds_read_b128 v[156:159], v56 offset:58368
s_waitcnt lgkmcnt(7)
v_mfma_f32_32x32x16_bf16 v[96:111], v[128:131], a[144:147], v[96:111]
s_mov_b32 s91, 925353388
v_add_f32 v252, s91, v245
v_rsq_f32 v13, v252
s_waitcnt vmcnt(2)
ds_read_b128 v[160:163], v56 offset:59392
s_waitcnt lgkmcnt(7)
v_mfma_f32_32x32x16_bf16 v[64:79], v[132:135], a[148:151], v[64:79]
ds_read_b128 v[164:167], v56 offset:60416
s_waitcnt lgkmcnt(7)
v_mfma_f32_32x32x16_bf16 v[80:95], v[136:139], a[148:151], v[80:95]
v_lshlrev_b32 v15, 4, v3
s_mov_b32 s91, 1069066811
v_mul_f32 v14, s91, v13
s_waitcnt lgkmcnt(6)
v_mfma_f32_32x32x16_bf16 v[96:111], v[140:143], a[148:151], v[96:111]
v_accvgpr_read_b32 v57, a220
v_accvgpr_read_b32 v58, a221
s_waitcnt vmcnt(1)
s_waitcnt lgkmcnt(5)
v_mfma_f32_32x32x16_bf16 v[64:79], v[144:147], a[152:155], v[64:79]
s_waitcnt lgkmcnt(4)
v_mfma_f32_32x32x16_bf16 v[80:95], v[148:151], a[152:155], v[80:95]
s_waitcnt lgkmcnt(3)
v_mfma_f32_32x32x16_bf16 v[96:111], v[152:155], a[152:155], v[96:111]
s_waitcnt vmcnt(0)
s_waitcnt lgkmcnt(2)
v_mfma_f32_32x32x16_bf16 v[64:79], v[156:159], a[156:159], v[64:79]
s_waitcnt lgkmcnt(1)
v_mfma_f32_32x32x16_bf16 v[80:95], v[160:163], a[156:159], v[80:95]
s_waitcnt lgkmcnt(0)
v_mfma_f32_32x32x16_bf16 v[96:111], v[164:167], a[156:159], v[96:111]
s_waitcnt lgkmcnt(0)
s_barrier
ds_read_b128 v[208:211], v15 offset:160
ds_read_b128 v[212:215], v15 offset:192
ds_read_b128 v[216:219], v15 offset:224
ds_read_b128 v[220:223], v15 offset:256
ds_read_b128 v[224:227], v15 offset:288
s_waitcnt lgkmcnt(4)
s_nop 1
v_pk_fma_f32 v[208:209], v[12:13], v[208:209], v[84:85] op_sel_hi:[0,1,1]
v_pk_mul_f32 v[208:209], v[208:209], v[12:13] op_sel:[0,1] op_sel_hi:[1,1]
v_pk_fma_f32 v[210:211], v[12:13], v[210:211], v[86:87] op_sel_hi:[0,1,1]
v_pk_mul_f32 v[210:211], v[210:211], v[12:13] op_sel:[0,1] op_sel_hi:[1,1]
v_cvt_pk_bf16_f32 v208, v208, v209
v_cvt_pk_bf16_f32 v209, v210, v211
ds_write_b64 v58, v[208:209] offset:0
s_waitcnt lgkmcnt(4)
v_pk_fma_f32 v[212:213], v[12:13], v[212:213], v[88:89] op_sel_hi:[0,1,1]
v_pk_mul_f32 v[212:213], v[212:213], v[12:13] op_sel:[0,1] op_sel_hi:[1,1]
s_add_u32 m0, s4, 30720
s_add_u32 s5, s65, 40960
buffer_load_dwordx4 v6, s[32:35], s5 offen sc1 lds
v_pk_fma_f32 v[214:215], v[12:13], v[214:215], v[90:91] op_sel_hi:[0,1,1]
v_pk_mul_f32 v[214:215], v[214:215], v[12:13] op_sel:[0,1] op_sel_hi:[1,1]
v_cvt_pk_bf16_f32 v212, v212, v213
v_cvt_pk_bf16_f32 v213, v214, v215
ds_write_b64 v58, v[212:213] offset:16
s_waitcnt lgkmcnt(4)
v_pk_fma_f32 v[216:217], v[12:13], v[216:217], v[92:93] op_sel_hi:[0,1,1]
v_pk_mul_f32 v[216:217], v[216:217], v[12:13] op_sel:[0,1] op_sel_hi:[1,1]
v_pk_fma_f32 v[218:219], v[12:13], v[218:219], v[94:95] op_sel_hi:[0,1,1]
v_pk_mul_f32 v[218:219], v[218:219], v[12:13] op_sel:[0,1] op_sel_hi:[1,1]
v_cvt_pk_bf16_f32 v216, v216, v217
s_add_u32 m0, s4, 34816
s_add_u32 s5, s65, 45056
buffer_load_dwordx4 v6, s[32:35], s5 offen sc1 lds
v_cvt_pk_bf16_f32 v217, v218, v219
ds_write_b64 v58, v[216:217] offset:32
s_waitcnt lgkmcnt(4)
v_pk_fma_f32 v[220:221], v[12:13], v[220:221], v[96:97] op_sel_hi:[0,1,1]
v_pk_mul_f32 v[220:221], v[220:221], v[12:13] op_sel:[0,1] op_sel_hi:[1,1]
v_pk_fma_f32 v[222:223], v[12:13], v[222:223], v[98:99] op_sel_hi:[0,1,1]
v_pk_mul_f32 v[222:223], v[222:223], v[12:13] op_sel:[0,1] op_sel_hi:[1,1]
v_cvt_pk_bf16_f32 v220, v220, v221
v_cvt_pk_bf16_f32 v221, v222, v223
ds_write_b64 v58, v[220:221] offset:48
s_waitcnt lgkmcnt(4)
v_pk_fma_f32 v[224:225], v[12:13], v[224:225], v[100:101] op_sel_hi:[0,1,1]
s_add_u32 m0, s4, 38912
s_add_u32 s5, s65, 49152
buffer_load_dwordx4 v6, s[32:35], s5 offen sc1 lds
v_pk_mul_f32 v[224:225], v[224:225], v[12:13] op_sel:[0,1] op_sel_hi:[1,1]
v_pk_fma_f32 v[226:227], v[12:13], v[226:227], v[102:103] op_sel_hi:[0,1,1]
v_pk_mul_f32 v[226:227], v[226:227], v[12:13] op_sel:[0,1] op_sel_hi:[1,1]
v_cvt_pk_bf16_f32 v224, v224, v225
v_cvt_pk_bf16_f32 v225, v226, v227
ds_write_b64 v58, v[224:225] offset:64
v_mov_b32 v182, 0x3f80
v_cmp_eq_u32 vcc, 0, v3
v_mov_b32 v183, 0
s_nop 0
v_cndmask_b32 v182, 0, v182, vcc
ds_write_b64 v58, v[182:183] offset:80
ds_read_b128 v[168:171], v15 offset:0
ds_read_b128 v[172:175], v15 offset:32
ds_read_b128 v[176:179], v15 offset:64
ds_read_b128 v[180:183], v15 offset:96
ds_read_b128 v[184:187], v15 offset:128
s_waitcnt lgkmcnt(0)
v_pk_fma_f32 v[168:169], v[12:13], v[168:169], v[64:65] op_sel_hi:[0,1,1]
v_pk_fma_f32 v[170:171], v[12:13], v[170:171], v[66:67] op_sel_hi:[0,1,1]
v_cvt_pk_bf16_f32 v188, v168, v169
v_cvt_pk_bf16_f32 v189, v170, v171
v_pk_fma_f32 v[172:173], v[12:13], v[172:173], v[68:69] op_sel_hi:[0,1,1]
v_pk_fma_f32 v[174:175], v[12:13], v[174:175], v[70:71] op_sel_hi:[0,1,1]
v_cvt_pk_bf16_f32 v190, v172, v173
v_cvt_pk_bf16_f32 v191, v174, v175
v_pk_fma_f32 v[176:177], v[12:13], v[176:177], v[72:73] op_sel_hi:[0,1,1]
v_pk_fma_f32 v[178:179], v[12:13], v[178:179], v[74:75] op_sel_hi:[0,1,1]
v_cvt_pk_bf16_f32 v192, v176, v177
v_cvt_pk_bf16_f32 v193, v178, v179
v_pk_fma_f32 v[180:181], v[12:13], v[180:181], v[76:77] op_sel_hi:[0,1,1]
v_pk_fma_f32 v[182:183], v[12:13], v[182:183], v[78:79] op_sel_hi:[0,1,1]
s_add_u32 m0, s4, 43008
s_add_u32 s5, s65, 53248
buffer_load_dwordx4 v6, s[32:35], s5 offen sc1 lds
v_cvt_pk_bf16_f32 v194, v180, v181
v_cvt_pk_bf16_f32 v195, v182, v183
v_pk_fma_f32 v[184:185], v[12:13], v[184:185], v[80:81] op_sel_hi:[0,1,1]
v_pk_fma_f32 v[186:187], v[12:13], v[186:187], v[82:83] op_sel_hi:[0,1,1]
v_cvt_pk_bf16_f32 v196, v184, v185
v_cvt_pk_bf16_f32 v197, v186, v187
v_mov_b32 v198, 0
v_mov_b32 v199, 0
v_mfma_f32_32x32x16_bf16 v[200:215], a[192:195], v[188:191], 0
v_mfma_f32_32x32x16_bf16 v[216:231], a[204:207], v[188:191], 0
v_mfma_f32_32x32x16_bf16 v[200:215], a[196:199], v[192:195], v[200:215]
v_mfma_f32_32x32x16_bf16 v[216:231], a[208:211], v[192:195], v[216:231]
v_mfma_f32_32x32x16_bf16 v[200:215], a[200:203], v[196:199], v[200:215]
v_mfma_f32_32x32x16_bf16 v[216:231], a[212:215], v[196:199], v[216:231]
s_nop 10
v_max3_f32 v168, v200, v201, v202
v_min3_f32 v169, v200, v201, v202
s_add_u32 m0, s4, 47104
s_add_u32 s5, s65, 57344
buffer_load_dwordx4 v6, s[32:35], s5 offen sc1 lds
v_max3_f32 v168, v168, v203, v204
v_min3_f32 v169, v169, v203, v204
v_max3_f32 v168, v168, v205, v206
v_min3_f32 v169, v169, v205, v206
v_max3_f32 v168, v168, v207, v208
v_min3_f32 v169, v169, v207, v208
v_max3_f32 v168, v168, v209, v210
v_min3_f32 v169, v169, v209, v210
v_max3_f32 v168, v168, v211, v212
v_min3_f32 v169, v169, v211, v212
v_max3_f32 v168, v168, v213, v214
v_min3_f32 v169, v169, v213, v214
v_max3_f32 v168, v168, v215, v216
v_min3_f32 v169, v169, v215, v216
v_max3_f32 v168, v168, v217, v218
v_min3_f32 v169, v169, v217, v218
s_add_u32 m0, s4, 51200
s_add_u32 s5, s65, 61440
buffer_load_dwordx4 v6, s[32:35], s5 offen sc1 lds
v_max_f32 v168, v168, v219
v_min_f32 v169, v169, v219
v_mul_f32 v168, v168, v14
v_mul_f32 v169, v169, v14
v_pk_fma_f32 v[172:173], v[200:201], v[14:15], v[168:169] op_sel_hi:[1,0,0] neg_lo:[0,0,1] neg_hi:[0,0,1]
v_pk_fma_f32 v[220:221], v[200:201], v[14:15], v[168:169] op_sel:[0,0,1] op_sel_hi:[1,0,1] neg_lo:[1,0,0] neg_hi:[1,0,0]
v_pk_fma_f32 v[174:175], v[202:203], v[14:15], v[168:169] op_sel_hi:[1,0,0] neg_lo:[0,0,1] neg_hi:[0,0,1]
v_pk_fma_f32 v[222:223], v[202:203], v[14:15], v[168:169] op_sel:[0,0,1] op_sel_hi:[1,0,1] neg_lo:[1,0,0] neg_hi:[1,0,0]
v_pk_fma_f32 v[176:177], v[204:205], v[14:15], v[168:169] op_sel_hi:[1,0,0] neg_lo:[0,0,1] neg_hi:[0,0,1]
v_pk_fma_f32 v[224:225], v[204:205], v[14:15], v[168:169] op_sel:[0,0,1] op_sel_hi:[1,0,1] neg_lo:[1,0,0] neg_hi:[1,0,0]
v_pk_fma_f32 v[178:179], v[206:207], v[14:15], v[168:169] op_sel_hi:[1,0,0] neg_lo:[0,0,1] neg_hi:[0,0,1]
v_pk_fma_f32 v[226:227], v[206:207], v[14:15], v[168:169] op_sel:[0,0,1] op_sel_hi:[1,0,1] neg_lo:[1,0,0] neg_hi:[1,0,0]
v_pk_fma_f32 v[180:181], v[208:209], v[14:15], v[168:169] op_sel_hi:[1,0,0] neg_lo:[0,0,1] neg_hi:[0,0,1]
v_pk_fma_f32 v[228:229], v[208:209], v[14:15], v[168:169] op_sel:[0,0,1] op_sel_hi:[1,0,1] neg_lo:[1,0,0] neg_hi:[1,0,0]
v_pk_fma_f32 v[182:183], v[210:211], v[14:15], v[168:169] op_sel_hi:[1,0,0] neg_lo:[0,0,1] neg_hi:[0,0,1]
v_pk_fma_f32 v[230:231], v[210:211], v[14:15], v[168:169] op_sel:[0,0,1] op_sel_hi:[1,0,1] neg_lo:[1,0,0] neg_hi:[1,0,0]
s_add_u32 m0, s4, 55296
s_add_u32 s5, s65, 65536
buffer_load_dwordx4 v6, s[32:35], s5 offen sc1 lds
v_pk_fma_f32 v[184:185], v[212:213], v[14:15], v[168:169] op_sel_hi:[1,0,0] neg_lo:[0,0,1] neg_hi:[0,0,1]
v_pk_fma_f32 v[232:233], v[212:213], v[14:15], v[168:169] op_sel:[0,0,1] op_sel_hi:[1,0,1] neg_lo:[1,0,0] neg_hi:[1,0,0]
v_pk_fma_f32 v[186:187], v[214:215], v[14:15], v[168:169] op_sel_hi:[1,0,0] neg_lo:[0,0,1] neg_hi:[0,0,1]
v_pk_fma_f32 v[234:235], v[214:215], v[14:15], v[168:169] op_sel:[0,0,1] op_sel_hi:[1,0,1] neg_lo:[1,0,0] neg_hi:[1,0,0]
v_pk_fma_f32 v[188:189], v[216:217], v[14:15], v[168:169] op_sel_hi:[1,0,0] neg_lo:[0,0,1] neg_hi:[0,0,1]
v_pk_fma_f32 v[236:237], v[216:217], v[14:15], v[168:169] op_sel:[0,0,1] op_sel_hi:[1,0,1] neg_lo:[1,0,0] neg_hi:[1,0,0]
v_pk_fma_f32 v[190:191], v[218:219], v[14:15], v[168:169] op_sel_hi:[1,0,0] neg_lo:[0,0,1] neg_hi:[0,0,1]
v_pk_fma_f32 v[238:239], v[218:219], v[14:15], v[168:169] op_sel:[0,0,1] op_sel_hi:[1,0,1] neg_lo:[1,0,0] neg_hi:[1,0,0]
v_exp_f32 v172, v172
v_exp_f32 v220, v220
v_exp_f32 v173, v173
v_exp_f32 v221, v221
v_exp_f32 v174, v174
v_exp_f32 v222, v222
v_exp_f32 v175, v175
v_exp_f32 v223, v223
s_add_u32 m0, s4, 59392
s_add_u32 s5, s65, 69632
buffer_load_dwordx4 v6, s[32:35], s5 offen sc1 lds
v_exp_f32 v176, v176
v_exp_f32 v224, v224
v_exp_f32 v177, v177
v_exp_f32 v225, v225
v_exp_f32 v178, v178
v_exp_f32 v226, v226
v_exp_f32 v179, v179
v_exp_f32 v227, v227
v_exp_f32 v180, v180
v_exp_f32 v228, v228
v_exp_f32 v181, v181
v_exp_f32 v229, v229
v_exp_f32 v182, v182
v_exp_f32 v230, v230
v_exp_f32 v183, v183
v_exp_f32 v231, v231
s_add_u32 m0, s4, 63488
s_add_u32 s5, s65, 73728
buffer_load_dwordx4 v6, s[32:35], s5 offen sc1 lds
v_exp_f32 v184, v184
v_exp_f32 v232, v232
v_exp_f32 v185, v185
v_exp_f32 v233, v233
v_exp_f32 v186, v186
v_exp_f32 v234, v234
v_exp_f32 v187, v187
v_exp_f32 v235, v235
v_exp_f32 v188, v188
v_exp_f32 v236, v236
v_exp_f32 v189, v189
v_exp_f32 v237, v237
v_exp_f32 v190, v190
v_exp_f32 v238, v238
v_exp_f32 v191, v191
v_exp_f32 v239, v239
s_add_u32 m0, s4, 67584
s_add_u32 s5, s65, 77824
buffer_load_dwordx4 v6, s[32:35], s5 offen sc1 lds
v_pk_add_f32 v[168:169], v[172:173], v[174:175]
v_pk_add_f32 v[170:171], v[220:221], v[222:223]
v_pk_add_f32 v[168:169], v[168:169], v[176:177]
v_pk_add_f32 v[170:171], v[170:171], v[224:225]
v_pk_add_f32 v[168:169], v[168:169], v[178:179]
v_pk_add_f32 v[170:171], v[170:171], v[226:227]
v_pk_add_f32 v[168:169], v[168:169], v[180:181]
v_pk_add_f32 v[170:171], v[170:171], v[228:229]
v_pk_add_f32 v[168:169], v[168:169], v[182:183]
v_pk_add_f32 v[170:171], v[170:171], v[230:231]
v_pk_add_f32 v[168:169], v[168:169], v[184:185]
v_pk_add_f32 v[170:171], v[170:171], v[232:233]
v_pk_add_f32 v[168:169], v[168:169], v[186:187]
v_pk_add_f32 v[170:171], v[170:171], v[234:235]
v_pk_add_f32 v[168:169], v[168:169], v[188:189]
v_pk_add_f32 v[170:171], v[170:171], v[236:237]
v_pk_add_f32 v[168:169], v[168:169], v[190:191]
v_pk_add_f32 v[170:171], v[170:171], v[238:239]
v_add_f32 v168, v168, v169
v_add_f32 v170, v170, v171
v_rcp_f32 v168, v168
v_rcp_f32 v170, v170
v_pk_mul_f32 v[172:173], v[172:173], v[168:169] op_sel_hi:[1,0]
v_pk_mul_f32 v[220:221], v[220:221], v[170:171] op_sel_hi:[1,0]
v_pk_mul_f32 v[174:175], v[174:175], v[168:169] op_sel_hi:[1,0]
v_pk_mul_f32 v[222:223], v[222:223], v[170:171] op_sel_hi:[1,0]
v_pk_mul_f32 v[176:177], v[176:177], v[168:169] op_sel_hi:[1,0]
v_pk_mul_f32 v[224:225], v[224:225], v[170:171] op_sel_hi:[1,0]
v_pk_mul_f32 v[178:179], v[178:179], v[168:169] op_sel_hi:[1,0]
v_pk_mul_f32 v[226:227], v[226:227], v[170:171] op_sel_hi:[1,0]
v_pk_mul_f32 v[180:181], v[180:181], v[168:169] op_sel_hi:[1,0]
v_pk_mul_f32 v[228:229], v[228:229], v[170:171] op_sel_hi:[1,0]
v_pk_mul_f32 v[182:183], v[182:183], v[168:169] op_sel_hi:[1,0]
v_pk_mul_f32 v[230:231], v[230:231], v[170:171] op_sel_hi:[1,0]
v_pk_mul_f32 v[184:185], v[184:185], v[168:169] op_sel_hi:[1,0]
v_pk_mul_f32 v[232:233], v[232:233], v[170:171] op_sel_hi:[1,0]
v_pk_mul_f32 v[186:187], v[186:187], v[168:169] op_sel_hi:[1,0]
v_pk_mul_f32 v[234:235], v[234:235], v[170:171] op_sel_hi:[1,0]
v_pk_mul_f32 v[188:189], v[188:189], v[168:169] op_sel_hi:[1,0]
v_pk_mul_f32 v[236:237], v[236:237], v[170:171] op_sel_hi:[1,0]
v_pk_mul_f32 v[190:191], v[190:191], v[168:169] op_sel_hi:[1,0]
v_pk_mul_f32 v[238:239], v[238:239], v[170:171] op_sel_hi:[1,0]
v_cvt_pk_bf16_f32 v36, v172, v173
v_cvt_pk_bf16_f32 v46, v220, v221
v_cvt_pk_bf16_f32 v37, v174, v175
v_cvt_pk_bf16_f32 v47, v222, v223
v_cvt_pk_bf16_f32 v38, v176, v177
v_cvt_pk_bf16_f32 v48, v224, v225
v_cvt_pk_bf16_f32 v39, v178, v179
v_cvt_pk_bf16_f32 v49, v226, v227
v_cvt_pk_bf16_f32 v40, v180, v181
v_cvt_pk_bf16_f32 v50, v228, v229
v_cvt_pk_bf16_f32 v41, v182, v183
v_cvt_pk_bf16_f32 v51, v230, v231
v_cvt_pk_bf16_f32 v42, v184, v185
v_cvt_pk_bf16_f32 v52, v232, v233
v_cvt_pk_bf16_f32 v43, v186, v187
v_cvt_pk_bf16_f32 v53, v234, v235
v_cvt_pk_bf16_f32 v44, v188, v189
v_cvt_pk_bf16_f32 v54, v236, v237
v_cvt_pk_bf16_f32 v45, v190, v191
v_cvt_pk_bf16_f32 v55, v238, v239
ds_write_b128 v57, v[36:39] offset:10240
ds_write_b128 v57, v[40:43] offset:10256
ds_write_b128 v57, v[44:47] offset:10272
ds_write_b128 v57, v[48:51] offset:10288
ds_write_b128 v57, v[52:55] offset:10304
v_accvgpr_read_b32 v228, a222
v_accvgpr_read_b32 v229, a223
v_accvgpr_read_b32 v231, a224
v_accvgpr_read_b32 v232, a225
s_lshl_b32 s56, s47, 20
s_add_u32 s56, s56, 1048576
s_lshl_b32 s57, s42, 16
s_add_u32 s56, s56, s57
s_lshl_b32 s57, s41, 12
s_add_u32 s56, s56, s57
s_waitcnt lgkmcnt(0)
s_barrier
ds_read_b64_tr_b16 v[192:193], v229 offset:0
ds_read_b64_tr_b16 v[194:195], v229 offset:1536
ds_read_b64_tr_b16 v[196:197], v228 offset:10240
ds_read_b64_tr_b16 v[198:199], v228 offset:12800
ds_read_b64_tr_b16 v[200:201], v228 offset:10272
ds_read_b64_tr_b16 v[202:203], v228 offset:12832
ds_read_b64_tr_b16 v[204:205], v228 offset:10304
ds_read_b64_tr_b16 v[206:207], v228 offset:12864
ds_read_b64_tr_b16 v[208:209], v229 offset:3072
ds_read_b64_tr_b16 v[210:211], v229 offset:4608
ds_read_b64_tr_b16 v[212:213], v228 offset:15360
ds_read_b64_tr_b16 v[214:215], v228 offset:17920
ds_read_b64_tr_b16 v[216:217], v228 offset:15392
ds_read_b64_tr_b16 v[218:219], v228 offset:17952
s_waitcnt lgkmcnt(6)
ds_read_b64_tr_b16 v[220:221], v228 offset:15424
ds_read_b64_tr_b16 v[222:223], v228 offset:17984
v_mfma_f32_16x16x32_bf16 v[176:179], v[196:199], v[192:195], 0
v_mfma_f32_16x16x32_bf16 v[180:183], v[200:203], v[192:195], 0
v_mfma_f32_16x16x32_bf16 v[184:187], v[204:207], v[192:195], 0
ds_read_b64_tr_b16 v[192:193], v229 offset:6144
ds_read_b64_tr_b16 v[194:195], v229 offset:7680
ds_read_b64_tr_b16 v[196:197], v228 offset:20480
ds_read_b64_tr_b16 v[198:199], v228 offset:23040
ds_read_b64_tr_b16 v[200:201], v228 offset:20512
ds_read_b64_tr_b16 v[202:203], v228 offset:23072
s_waitcnt lgkmcnt(6)
ds_read_b64_tr_b16 v[204:205], v228 offset:20544
ds_read_b64_tr_b16 v[206:207], v228 offset:23104
v_mfma_f32_16x16x32_bf16 v[176:179], v[212:215], v[208:211], v[176:179]
v_mfma_f32_16x16x32_bf16 v[180:183], v[216:219], v[208:211], v[180:183]
v_mfma_f32_16x16x32_bf16 v[184:187], v[220:223], v[208:211], v[184:187]
ds_read_b64_tr_b16 v[208:209], v229 offset:9216
ds_read_b64_tr_b16 v[210:211], v229 offset:10752
ds_read_b64_tr_b16 v[212:213], v228 offset:25600
ds_read_b64_tr_b16 v[214:215], v228 offset:28160
ds_read_b64_tr_b16 v[216:217], v228 offset:25632
ds_read_b64_tr_b16 v[218:219], v228 offset:28192
s_waitcnt lgkmcnt(6)
ds_read_b64_tr_b16 v[220:221], v228 offset:25664
ds_read_b64_tr_b16 v[222:223], v228 offset:28224
v_mfma_f32_16x16x32_bf16 v[176:179], v[196:199], v[192:195], v[176:179]
v_mfma_f32_16x16x32_bf16 v[180:183], v[200:203], v[192:195], v[180:183]
v_mfma_f32_16x16x32_bf16 v[184:187], v[204:207], v[192:195], v[184:187]
s_waitcnt lgkmcnt(0)
v_mfma_f32_16x16x32_bf16 v[176:179], v[212:215], v[208:211], v[176:179]
v_mfma_f32_16x16x32_bf16 v[180:183], v[216:219], v[208:211], v[180:183]
v_mfma_f32_16x16x32_bf16 v[184:187], v[220:223], v[208:211], v[184:187]
s_nop 5
v_cvt_pk_bf16_f32 v176, v176, v177
v_cvt_pk_bf16_f32 v177, v178, v179
buffer_store_dwordx2 v[176:177], v231, s[32:35], s56 offen offset:0 sc1
v_cvt_pk_bf16_f32 v180, v180, v181
v_cvt_pk_bf16_f32 v181, v182, v183
buffer_store_dwordx2 v[180:181], v231, s[32:35], s56 offen offset:32 sc1
v_cvt_pk_bf16_f32 v184, v184, v185
v_cvt_pk_bf16_f32 v185, v186, v187
buffer_store_dwordx2 v[184:185], v232, s[32:35], s56 offen offset:64 sc1
v_accvgpr_read_b32 v59, a233
s_barrier
ds_read_b128 v[128:131], v59 offset:0
ds_read_b128 v[132:135], v59 offset:768
ds_read_b128 v[136:139], v59 offset:1536
ds_read_b128 v[140:143], v59 offset:2304
ds_read_b128 v[144:147], v59 offset:3072
ds_read_b128 v[148:151], v59 offset:3840
ds_read_b128 v[152:155], v59 offset:4608
ds_read_b128 v[156:159], v59 offset:5376
s_waitcnt lgkmcnt(7)
v_mfma_f32_32x32x16_bf16 v[112:127], v[128:131], a[0:3], 0
s_add_u32 m0, s4, 102400
s_add_u32 s5, s65, 0
buffer_load_dwordx4 v6, s[32:35], s5 offen sc1 lds
ds_read_b128 v[160:163], v59 offset:6144
s_waitcnt lgkmcnt(7)
v_mfma_f32_32x32x16_bf16 v[112:127], v[132:135], a[4:7], v[112:127]
ds_read_b128 v[164:167], v59 offset:6912
s_waitcnt lgkmcnt(7)
v_mfma_f32_32x32x16_bf16 v[112:127], v[136:139], a[8:11], v[112:127]
s_add_u32 m0, s4, 106496
s_add_u32 s5, s65, 4096
buffer_load_dwordx4 v6, s[32:35], s5 offen sc1 lds
ds_read_b128 v[128:131], v59 offset:7680
s_waitcnt lgkmcnt(7)
v_mfma_f32_32x32x16_bf16 v[112:127], v[140:143], a[12:15], v[112:127]
ds_read_b128 v[132:135], v59 offset:8448
s_waitcnt lgkmcnt(7)
v_mfma_f32_32x32x16_bf16 v[112:127], v[144:147], a[16:19], v[112:127]
s_add_u32 m0, s4, 110592
s_add_u32 s5, s65, 8192
buffer_load_dwordx4 v6, s[32:35], s5 offen sc1 lds
ds_read_b128 v[136:139], v59 offset:9216
s_waitcnt lgkmcnt(7)
v_mfma_f32_32x32x16_bf16 v[112:127], v[148:151], a[20:23], v[112:127]
ds_read_b128 v[140:143], v59 offset:9984
s_waitcnt lgkmcnt(7)
v_mfma_f32_32x32x16_bf16 v[112:127], v[152:155], a[24:27], v[112:127]
s_add_u32 m0, s4, 114688
s_add_u32 s5, s65, 12288
buffer_load_dwordx4 v6, s[32:35], s5 offen sc1 lds
ds_read_b128 v[144:147], v59 offset:10752
s_waitcnt lgkmcnt(7)
v_mfma_f32_32x32x16_bf16 v[112:127], v[156:159], a[28:31], v[112:127]
ds_read_b128 v[148:151], v59 offset:11520
s_waitcnt lgkmcnt(7)
v_mfma_f32_32x32x16_bf16 v[112:127], v[160:163], a[32:35], v[112:127]
s_add_u32 m0, s4, 118784
s_add_u32 s5, s65, 16384
buffer_load_dwordx4 v6, s[32:35], s5 offen sc1 lds
ds_read_b128 v[152:155], v59 offset:12288
s_waitcnt lgkmcnt(7)
v_mfma_f32_32x32x16_bf16 v[112:127], v[164:167], a[36:39], v[112:127]
ds_read_b128 v[156:159], v59 offset:13056
s_waitcnt lgkmcnt(7)
v_mfma_f32_32x32x16_bf16 v[112:127], v[128:131], a[40:43], v[112:127]
s_add_u32 m0, s4, 122880
s_add_u32 s5, s65, 20480
buffer_load_dwordx4 v6, s[32:35], s5 offen sc1 lds
ds_read_b128 v[160:163], v59 offset:13824
s_waitcnt lgkmcnt(7)
v_mfma_f32_32x32x16_bf16 v[112:127], v[132:135], a[44:47], v[112:127]
ds_read_b128 v[164:167], v59 offset:14592
s_waitcnt lgkmcnt(7)
v_mfma_f32_32x32x16_bf16 v[112:127], v[136:139], a[48:51], v[112:127]
s_add_u32 m0, s4, 126976
s_add_u32 s5, s65, 24576
buffer_load_dwordx4 v6, s[32:35], s5 offen sc1 lds
ds_read_b128 v[128:131], v59 offset:15360
s_waitcnt lgkmcnt(7)
v_mfma_f32_32x32x16_bf16 v[112:127], v[140:143], a[52:55], v[112:127]
ds_read_b128 v[132:135], v59 offset:16128
s_waitcnt lgkmcnt(7)
v_mfma_f32_32x32x16_bf16 v[112:127], v[144:147], a[56:59], v[112:127]
s_add_u32 m0, s4, 131072
s_add_u32 s5, s65, 28672
buffer_load_dwordx4 v6, s[32:35], s5 offen sc1 lds
ds_read_b128 v[136:139], v59 offset:16896
s_waitcnt lgkmcnt(7)
v_mfma_f32_32x32x16_bf16 v[112:127], v[148:151], a[60:63], v[112:127]
ds_read_b128 v[140:143], v59 offset:17664
s_waitcnt lgkmcnt(7)
v_mfma_f32_32x32x16_bf16 v[112:127], v[152:155], a[64:67], v[112:127]
s_add_u32 m0, s4, 135168
s_add_u32 s5, s65, 32768
buffer_load_dwordx4 v6, s[32:35], s5 offen sc1 lds
ds_read_b128 v[144:147], v59 offset:18432
s_waitcnt lgkmcnt(7)
v_mfma_f32_32x32x16_bf16 v[112:127], v[156:159], a[68:71], v[112:127]
ds_read_b128 v[148:151], v59 offset:19200
s_waitcnt lgkmcnt(7)
v_mfma_f32_32x32x16_bf16 v[112:127], v[160:163], a[72:75], v[112:127]
s_add_u32 m0, s4, 139264
s_add_u32 s5, s65, 36864
buffer_load_dwordx4 v6, s[32:35], s5 offen sc1 lds
ds_read_b128 v[152:155], v59 offset:19968
s_waitcnt lgkmcnt(7)
v_mfma_f32_32x32x16_bf16 v[112:127], v[164:167], a[76:79], v[112:127]
ds_read_b128 v[156:159], v59 offset:20736
s_waitcnt lgkmcnt(7)
v_mfma_f32_32x32x16_bf16 v[112:127], v[128:131], a[80:83], v[112:127]
ds_read_b128 v[160:163], v59 offset:21504
s_waitcnt lgkmcnt(7)
v_mfma_f32_32x32x16_bf16 v[112:127], v[132:135], a[84:87], v[112:127]
ds_read_b128 v[164:167], v59 offset:22272
s_waitcnt lgkmcnt(7)
v_mfma_f32_32x32x16_bf16 v[112:127], v[136:139], a[88:91], v[112:127]
ds_read_b128 v[128:131], v59 offset:23040
s_waitcnt lgkmcnt(7)
v_mfma_f32_32x32x16_bf16 v[112:127], v[140:143], a[92:95], v[112:127]
s_waitcnt vmcnt(10)
s_barrier
s_cmp_eq_u32 s40, 0
s_nop 8
s_cbranch_scc0 Larr_30
s_mov_b64 exec, 1
v_mov_b32 v168, s85
global_atomic_add v168, v11, s[30:31] sc1
s_mov_b64 exec, -1
s_nop 2
Larr_30:
ds_read_b128 v[132:135], v59 offset:23808
s_waitcnt lgkmcnt(7)
v_mfma_f32_32x32x16_bf16 v[112:127], v[144:147], a[96:99], v[112:127]
s_add_u32 m0, s4, 10240
s_add_u32 s5, s66, 0
buffer_load_dwordx4 v6, s[32:35], s5 offen sc1 lds
ds_read_b128 v[136:139], v59 offset:24576
s_waitcnt lgkmcnt(7)
v_mfma_f32_32x32x16_bf16 v[112:127], v[148:151], a[100:103], v[112:127]
s_add_u32 m0, s4, 14336
s_add_u32 s5, s66, 4096
buffer_load_dwordx4 v6, s[32:35], s5 offen sc1 lds
ds_read_b128 v[140:143], v59 offset:25344
s_waitcnt lgkmcnt(7)
v_mfma_f32_32x32x16_bf16 v[112:127], v[152:155], a[104:107], v[112:127]
s_add_u32 m0, s4, 18432
s_add_u32 s5, s66, 8192
buffer_load_dwordx4 v6, s[32:35], s5 offen sc1 lds
ds_read_b128 v[144:147], v59 offset:26112
s_waitcnt lgkmcnt(7)
v_mfma_f32_32x32x16_bf16 v[112:127], v[156:159], a[108:111], v[112:127]
s_add_u32 m0, s4, 22528
s_add_u32 s5, s66, 12288
buffer_load_dwordx4 v6, s[32:35], s5 offen sc1 lds
ds_read_b128 v[148:151], v59 offset:26880
s_waitcnt lgkmcnt(7)
v_mfma_f32_32x32x16_bf16 v[112:127], v[160:163], a[112:115], v[112:127]
s_mov_b32 m0, 0x30000
s_mov_b32 s5, 16384
s_sub_u32 s6, s40, 0
s_cmp_lt_u32 s6, 2
s_cselect_b32 s5, 16384, s5
s_add_u32 s6, s4, 26624
s_sub_u32 s7, s40, 0
s_cmp_lt_u32 s7, 2
s_cselect_b32 m0, s6, m0
s_add_u32 s5, s5, s66
buffer_load_dwordx4 v6, s[32:35], s5 offen sc1 lds
ds_read_b128 v[152:155], v59 offset:27648
s_waitcnt lgkmcnt(7)
v_mfma_f32_32x32x16_bf16 v[112:127], v[164:167], a[116:119], v[112:127]
ds_read_b128 v[156:159], v59 offset:28416
s_waitcnt lgkmcnt(7)
v_mfma_f32_32x32x16_bf16 v[112:127], v[128:131], a[120:123], v[112:127]
ds_read_b128 v[160:163], v59 offset:29184
s_waitcnt lgkmcnt(7)
v_mfma_f32_32x32x16_bf16 v[112:127], v[132:135], a[124:127], v[112:127]
ds_read_b128 v[164:167], v59 offset:29952
s_waitcnt lgkmcnt(7)
v_mfma_f32_32x32x16_bf16 v[112:127], v[136:139], a[128:131], v[112:127]
s_waitcnt lgkmcnt(6)
v_mfma_f32_32x32x16_bf16 v[112:127], v[140:143], a[132:135], v[112:127]
s_waitcnt lgkmcnt(5)
v_mfma_f32_32x32x16_bf16 v[112:127], v[144:147], a[136:139], v[112:127]
s_waitcnt lgkmcnt(4)
v_mfma_f32_32x32x16_bf16 v[112:127], v[148:151], a[140:143], v[112:127]
s_waitcnt lgkmcnt(3)
v_mfma_f32_32x32x16_bf16 v[112:127], v[152:155], a[144:147], v[112:127]
s_waitcnt lgkmcnt(2)
v_mfma_f32_32x32x16_bf16 v[112:127], v[156:159], a[148:151], v[112:127]
s_waitcnt lgkmcnt(1)
v_mfma_f32_32x32x16_bf16 v[112:127], v[160:163], a[152:155], v[112:127]
s_waitcnt lgkmcnt(0)
v_mfma_f32_32x32x16_bf16 v[112:127], v[164:167], a[156:159], v[112:127]
s_barrier
ds_read_b128 v[168:171], v15 offset:320
ds_read_b128 v[172:175], v15 offset:352
ds_read_b128 v[176:179], v15 offset:384
ds_read_b128 v[180:183], v15 offset:416
ds_read_b128 v[184:187], v15 offset:448
s_waitcnt lgkmcnt(0)
v_pk_fma_f32 v[168:169], v[12:13], v[168:169], v[104:105] op_sel_hi:[0,1,1]
v_pk_fma_f32 v[170:171], v[12:13], v[170:171], v[106:107] op_sel_hi:[0,1,1]
v_cvt_pk_bf16_f32 v188, v168, v169
v_cvt_pk_bf16_f32 v189, v170, v171
v_pk_fma_f32 v[172:173], v[12:13], v[172:173], v[108:109] op_sel_hi:[0,1,1]
v_pk_fma_f32 v[174:175], v[12:13], v[174:175], v[110:111] op_sel_hi:[0,1,1]
v_cvt_pk_bf16_f32 v190, v172, v173
v_cvt_pk_bf16_f32 v191, v174, v175
v_pk_fma_f32 v[176:177], v[12:13], v[176:177], v[112:113] op_sel_hi:[0,1,1]
v_pk_fma_f32 v[178:179], v[12:13], v[178:179], v[114:115] op_sel_hi:[0,1,1]
s_add_u32 m0, s4, 71680
s_add_u32 s5, s65, 81920
buffer_load_dwordx4 v6, s[32:35], s5 offen sc1 lds
v_cvt_pk_bf16_f32 v192, v176, v177
v_cvt_pk_bf16_f32 v193, v178, v179
v_pk_fma_f32 v[180:181], v[12:13], v[180:181], v[116:117] op_sel_hi:[0,1,1]
v_pk_fma_f32 v[182:183], v[12:13], v[182:183], v[118:119] op_sel_hi:[0,1,1]
v_cvt_pk_bf16_f32 v194, v180, v181
v_cvt_pk_bf16_f32 v195, v182, v183
v_pk_fma_f32 v[184:185], v[12:13], v[184:185], v[120:121] op_sel_hi:[0,1,1]
v_pk_fma_f32 v[186:187], v[12:13], v[186:187], v[122:123] op_sel_hi:[0,1,1]
v_cvt_pk_bf16_f32 v196, v184, v185
v_cvt_pk_bf16_f32 v197, v186, v187
v_mov_b32 v198, 0
v_mov_b32 v199, 0
s_add_u32 m0, s4, 75776
s_add_u32 s5, s65, 86016
buffer_load_dwordx4 v6, s[32:35], s5 offen sc1 lds
v_mfma_f32_32x32x16_bf16 v[200:215], a[192:195], v[188:191], 0
v_mfma_f32_32x32x16_bf16 v[216:231], a[204:207], v[188:191], 0
v_mfma_f32_32x32x16_bf16 v[200:215], a[196:199], v[192:195], v[200:215]
v_mfma_f32_32x32x16_bf16 v[216:231], a[208:211], v[192:195], v[216:231]
v_mfma_f32_32x32x16_bf16 v[200:215], a[200:203], v[196:199], v[200:215]
v_mfma_f32_32x32x16_bf16 v[216:231], a[212:215], v[196:199], v[216:231]
s_nop 10
v_max3_f32 v168, v200, v201, v202
v_min3_f32 v169, v200, v201, v202
v_max3_f32 v168, v168, v203, v204
v_min3_f32 v169, v169, v203, v204
v_max3_f32 v168, v168, v205, v206
v_min3_f32 v169, v169, v205, v206
s_add_u32 m0, s4, 79872
s_add_u32 s5, s65, 90112
buffer_load_dwordx4 v6, s[32:35], s5 offen sc1 lds
v_max3_f32 v168, v168, v207, v208
v_min3_f32 v169, v169, v207, v208
v_max3_f32 v168, v168, v209, v210
v_min3_f32 v169, v169, v209, v210
v_max3_f32 v168, v168, v211, v212
v_min3_f32 v169, v169, v211, v212
v_max3_f32 v168, v168, v213, v214
v_min3_f32 v169, v169, v213, v214
v_max3_f32 v168, v168, v215, v216
v_min3_f32 v169, v169, v215, v216
v_max3_f32 v168, v168, v217, v218
v_min3_f32 v169, v169, v217, v218
s_add_u32 m0, s4, 83968
s_add_u32 s5, s65, 94208
buffer_load_dwordx4 v6, s[32:35], s5 offen sc1 lds
v_max_f32 v168, v168, v219
v_min_f32 v169, v169, v219
v_mul_f32 v168, v168, v14
v_mul_f32 v169, v169, v14
v_pk_fma_f32 v[172:173], v[200:201], v[14:15], v[168:169] op_sel_hi:[1,0,0] neg_lo:[0,0,1] neg_hi:[0,0,1]
v_pk_fma_f32 v[220:221], v[200:201], v[14:15], v[168:169] op_sel:[0,0,1] op_sel_hi:[1,0,1] neg_lo:[1,0,0] neg_hi:[1,0,0]
v_pk_fma_f32 v[174:175], v[202:203], v[14:15], v[168:169] op_sel_hi:[1,0,0] neg_lo:[0,0,1] neg_hi:[0,0,1]
v_pk_fma_f32 v[222:223], v[202:203], v[14:15], v[168:169] op_sel:[0,0,1] op_sel_hi:[1,0,1] neg_lo:[1,0,0] neg_hi:[1,0,0]
v_pk_fma_f32 v[176:177], v[204:205], v[14:15], v[168:169] op_sel_hi:[1,0,0] neg_lo:[0,0,1] neg_hi:[0,0,1]
v_pk_fma_f32 v[224:225], v[204:205], v[14:15], v[168:169] op_sel:[0,0,1] op_sel_hi:[1,0,1] neg_lo:[1,0,0] neg_hi:[1,0,0]
v_pk_fma_f32 v[178:179], v[206:207], v[14:15], v[168:169] op_sel_hi:[1,0,0] neg_lo:[0,0,1] neg_hi:[0,0,1]
v_pk_fma_f32 v[226:227], v[206:207], v[14:15], v[168:169] op_sel:[0,0,1] op_sel_hi:[1,0,1] neg_lo:[1,0,0] neg_hi:[1,0,0]
s_add_u32 m0, s4, 88064
s_add_u32 s5, s65, 98304
buffer_load_dwordx4 v6, s[32:35], s5 offen sc1 lds
v_pk_fma_f32 v[180:181], v[208:209], v[14:15], v[168:169] op_sel_hi:[1,0,0] neg_lo:[0,0,1] neg_hi:[0,0,1]
v_pk_fma_f32 v[228:229], v[208:209], v[14:15], v[168:169] op_sel:[0,0,1] op_sel_hi:[1,0,1] neg_lo:[1,0,0] neg_hi:[1,0,0]
v_pk_fma_f32 v[182:183], v[210:211], v[14:15], v[168:169] op_sel_hi:[1,0,0] neg_lo:[0,0,1] neg_hi:[0,0,1]
v_pk_fma_f32 v[230:231], v[210:211], v[14:15], v[168:169] op_sel:[0,0,1] op_sel_hi:[1,0,1] neg_lo:[1,0,0] neg_hi:[1,0,0]
v_pk_fma_f32 v[184:185], v[212:213], v[14:15], v[168:169] op_sel_hi:[1,0,0] neg_lo:[0,0,1] neg_hi:[0,0,1]
v_pk_fma_f32 v[232:233], v[212:213], v[14:15], v[168:169] op_sel:[0,0,1] op_sel_hi:[1,0,1] neg_lo:[1,0,0] neg_hi:[1,0,0]
v_pk_fma_f32 v[186:187], v[214:215], v[14:15], v[168:169] op_sel_hi:[1,0,0] neg_lo:[0,0,1] neg_hi:[0,0,1]
v_pk_fma_f32 v[234:235], v[214:215], v[14:15], v[168:169] op_sel:[0,0,1] op_sel_hi:[1,0,1] neg_lo:[1,0,0] neg_hi:[1,0,0]
v_pk_fma_f32 v[188:189], v[216:217], v[14:15], v[168:169] op_sel_hi:[1,0,0] neg_lo:[0,0,1] neg_hi:[0,0,1]
v_pk_fma_f32 v[236:237], v[216:217], v[14:15], v[168:169] op_sel:[0,0,1] op_sel_hi:[1,0,1] neg_lo:[1,0,0] neg_hi:[1,0,0]
v_pk_fma_f32 v[190:191], v[218:219], v[14:15], v[168:169] op_sel_hi:[1,0,0] neg_lo:[0,0,1] neg_hi:[0,0,1]
v_pk_fma_f32 v[238:239], v[218:219], v[14:15], v[168:169] op_sel:[0,0,1] op_sel_hi:[1,0,1] neg_lo:[1,0,0] neg_hi:[1,0,0]
s_add_u32 m0, s4, 92160
s_add_u32 s5, s66, 18432
buffer_load_dwordx4 v6, s[32:35], s5 offen sc1 lds
v_exp_f32 v172, v172
v_exp_f32 v220, v220
v_exp_f32 v173, v173
v_exp_f32 v221, v221
v_exp_f32 v174, v174
v_exp_f32 v222, v222
v_exp_f32 v175, v175
v_exp_f32 v223, v223
v_exp_f32 v176, v176
v_exp_f32 v224, v224
v_exp_f32 v177, v177
v_exp_f32 v225, v225
s_add_u32 m0, s4, 96256
s_add_u32 s5, s66, 22528
buffer_load_dwordx4 v6, s[32:35], s5 offen sc1 lds
v_exp_f32 v178, v178
v_exp_f32 v226, v226
v_exp_f32 v179, v179
v_exp_f32 v227, v227
v_exp_f32 v180, v180
v_exp_f32 v228, v228
v_exp_f32 v181, v181
v_exp_f32 v229, v229
v_exp_f32 v182, v182
v_exp_f32 v230, v230
v_exp_f32 v183, v183
v_exp_f32 v231, v231
s_mov_b32 m0, 0x30000
s_mov_b32 s5, 26624
s_sub_u32 s6, s40, 0
s_cmp_lt_u32 s6, 1
s_cselect_b32 s5, 26624, s5
s_add_u32 s6, s4, 100352
s_sub_u32 s7, s40, 0
s_cmp_lt_u32 s7, 1
s_cselect_b32 m0, s6, m0
s_add_u32 s5, s5, s66
buffer_load_dwordx4 v6, s[32:35], s5 offen sc1 lds
v_exp_f32 v184, v184
v_exp_f32 v232, v232
v_exp_f32 v185, v185
v_exp_f32 v233, v233
v_exp_f32 v186, v186
v_exp_f32 v234, v234
v_exp_f32 v187, v187
v_exp_f32 v235, v235
v_exp_f32 v188, v188
v_exp_f32 v236, v236
v_exp_f32 v189, v189
v_exp_f32 v237, v237
v_exp_f32 v190, v190
v_exp_f32 v238, v238
v_exp_f32 v191, v191
v_exp_f32 v239, v239
v_pk_add_f32 v[168:169], v[172:173], v[174:175]
v_pk_add_f32 v[170:171], v[220:221], v[222:223]
v_pk_add_f32 v[168:169], v[168:169], v[176:177]
v_pk_add_f32 v[170:171], v[170:171], v[224:225]
v_pk_add_f32 v[168:169], v[168:169], v[178:179]
v_pk_add_f32 v[170:171], v[170:171], v[226:227]
v_pk_add_f32 v[168:169], v[168:169], v[180:181]
v_pk_add_f32 v[170:171], v[170:171], v[228:229]
v_pk_add_f32 v[168:169], v[168:169], v[182:183]
v_pk_add_f32 v[170:171], v[170:171], v[230:231]
v_pk_add_f32 v[168:169], v[168:169], v[184:185]
v_pk_add_f32 v[170:171], v[170:171], v[232:233]
v_pk_add_f32 v[168:169], v[168:169], v[186:187]
v_pk_add_f32 v[170:171], v[170:171], v[234:235]
v_pk_add_f32 v[168:169], v[168:169], v[188:189]
v_pk_add_f32 v[170:171], v[170:171], v[236:237]
v_pk_add_f32 v[168:169], v[168:169], v[190:191]
v_pk_add_f32 v[170:171], v[170:171], v[238:239]
v_add_f32 v168, v168, v169
v_add_f32 v170, v170, v171
v_rcp_f32 v168, v168
v_rcp_f32 v170, v170
v_pk_mul_f32 v[172:173], v[172:173], v[168:169] op_sel_hi:[1,0]
v_pk_mul_f32 v[220:221], v[220:221], v[170:171] op_sel_hi:[1,0]
v_pk_mul_f32 v[174:175], v[174:175], v[168:169] op_sel_hi:[1,0]
v_pk_mul_f32 v[222:223], v[222:223], v[170:171] op_sel_hi:[1,0]
v_pk_mul_f32 v[176:177], v[176:177], v[168:169] op_sel_hi:[1,0]
v_pk_mul_f32 v[224:225], v[224:225], v[170:171] op_sel_hi:[1,0]
v_pk_mul_f32 v[178:179], v[178:179], v[168:169] op_sel_hi:[1,0]
v_pk_mul_f32 v[226:227], v[226:227], v[170:171] op_sel_hi:[1,0]
v_pk_mul_f32 v[180:181], v[180:181], v[168:169] op_sel_hi:[1,0]
v_pk_mul_f32 v[228:229], v[228:229], v[170:171] op_sel_hi:[1,0]
v_pk_mul_f32 v[182:183], v[182:183], v[168:169] op_sel_hi:[1,0]
v_pk_mul_f32 v[230:231], v[230:231], v[170:171] op_sel_hi:[1,0]
v_pk_mul_f32 v[184:185], v[184:185], v[168:169] op_sel_hi:[1,0]
v_pk_mul_f32 v[232:233], v[232:233], v[170:171] op_sel_hi:[1,0]
v_pk_mul_f32 v[186:187], v[186:187], v[168:169] op_sel_hi:[1,0]
v_pk_mul_f32 v[234:235], v[234:235], v[170:171] op_sel_hi:[1,0]
v_pk_mul_f32 v[188:189], v[188:189], v[168:169] op_sel_hi:[1,0]
v_pk_mul_f32 v[236:237], v[236:237], v[170:171] op_sel_hi:[1,0]
v_pk_mul_f32 v[190:191], v[190:191], v[168:169] op_sel_hi:[1,0]
v_pk_mul_f32 v[238:239], v[238:239], v[170:171] op_sel_hi:[1,0]
v_cvt_pk_bf16_f32 v36, v172, v173
v_cvt_pk_bf16_f32 v46, v220, v221
v_cvt_pk_bf16_f32 v37, v174, v175
v_cvt_pk_bf16_f32 v47, v222, v223
v_cvt_pk_bf16_f32 v38, v176, v177
v_cvt_pk_bf16_f32 v48, v224, v225
v_cvt_pk_bf16_f32 v39, v178, v179
v_cvt_pk_bf16_f32 v49, v226, v227
v_cvt_pk_bf16_f32 v40, v180, v181
v_cvt_pk_bf16_f32 v50, v228, v229
v_cvt_pk_bf16_f32 v41, v182, v183
v_cvt_pk_bf16_f32 v51, v230, v231
v_cvt_pk_bf16_f32 v42, v184, v185
v_cvt_pk_bf16_f32 v52, v232, v233
v_cvt_pk_bf16_f32 v43, v186, v187
v_cvt_pk_bf16_f32 v53, v234, v235
v_cvt_pk_bf16_f32 v44, v188, v189
v_cvt_pk_bf16_f32 v54, v236, v237
v_cvt_pk_bf16_f32 v45, v190, v191
v_cvt_pk_bf16_f32 v55, v238, v239
s_lshl_b32 s56, s47, 4
s_add_u32 s56, s56, 48
s_cmp_eq_u32 s40, 1
s_nop 1
s_cbranch_scc0 Lsy_31
v_mov_b32 v168, s85
v_mov_b32 v169, s56
v_mov_b32 v171, 0xff
s_mov_b64 exec, 1
s_cmp_eq_u32 s53, 0
s_cselect_b32 s82, 0, 6000000
s_nop 1
Lp_33:
global_load_dword v170, v168, s[30:31] sc1
s_add_u32 s82, s82, 1
s_cmp_gt_u32 s82, 6000000
s_cbranch_scc1 Lpd_34_to
s_waitcnt vmcnt(0)
v_and_b32 v172, v171, v170
v_cmp_lt_u32 vcc, v172, v169
s_nop 4
s_cbranch_vccz Lpd_34
s_branch Lp_33
Lpd_34_to:
s_or_b32 s53, s53, 8
s_waitcnt vmcnt(0)
Lpd_34:
s_mov_b64 exec, -1
s_branch Lsye_32
Lsy_31:
Lsye_32:
s_barrier
v_accvgpr_read_b32 v169, a228
s_lshl_b32 s56, s47, 20
s_add_u32 s56, s56, 1048576
s_lshl_b32 s57, s42, 16
s_add_u32 s56, s56, s57
buffer_load_dwordx4 v[176:179], v169, s[32:35], s56 offen sc1
s_add_u32 s56, s56, 4096
buffer_load_dwordx4 v[180:183], v169, s[32:35], s56 offen sc1
s_add_u32 s56, s56, 4096
buffer_load_dwordx4 v[184:187], v169, s[32:35], s56 offen sc1
s_add_u32 s56, s56, 4096
buffer_load_dwordx4 v[188:191], v169, s[32:35], s56 offen sc1
s_add_u32 s56, s56, 4096
buffer_load_dwordx4 v[192:195], v169, s[32:35], s56 offen sc1
s_add_u32 s56, s56, 4096
buffer_load_dwordx4 v[196:199], v169, s[32:35], s56 offen sc1
s_add_u32 s56, s56, 4096
buffer_load_dwordx4 v[200:203], v169, s[32:35], s56 offen sc1
s_add_u32 s56, s56, 4096
buffer_load_dwordx4 v[204:207], v169, s[32:35], s56 offen sc1
s_add_u32 s56, s56, 4096
buffer_load_dwordx4 v[208:211], v169, s[32:35], s56 offen sc1
s_add_u32 s56, s56, 4096
buffer_load_dwordx4 v[212:215], v169, s[32:35], s56 offen sc1
s_add_u32 s56, s56, 4096
buffer_load_dwordx4 v[216:219], v169, s[32:35], s56 offen sc1
s_add_u32 s56, s56, 4096
buffer_load_dwordx4 v[220:223], v169, s[32:35], s56 offen sc1
s_add_u32 s56, s56, 4096
buffer_load_dwordx4 v[224:227], v169, s[32:35], s56 offen sc1
s_add_u32 s56, s56, 4096
buffer_load_dwordx4 v[228:231], v169, s[32:35], s56 offen sc1
s_add_u32 s56, s56, 4096
buffer_load_dwordx4 v[232:235], v169, s[32:35], s56 offen sc1
s_add_u32 s56, s56, 4096
buffer_load_dwordx4 v[236:239], v169, s[32:35], s56 offen sc1
v_accvgpr_read_b32 v170, a229
v_accvgpr_read_b32 v171, a230
v_accvgpr_read_b32 v172, a226
v_accvgpr_read_b32 v173, a227
v_accvgpr_read_b32 v174, a231
v_accvgpr_read_b32 v175, a232
s_lshl_b32 s56, s8, 22
s_add_u32 s56, s56, 33554432
s_mul_i32 s57, s41, 163840
s_add_u32 s56, s56, s57
s_mul_i32 s57, s40, 40960
s_add_u32 s56, s56, s57
s_lshl_b32 s57, s42, 10
s_add_u32 s58, s56, s57
s_lshr_b32 s57, s42, 2
s_add_u32 s57, s57, 16
s_lshl_b32 s57, s57, 10
s_add_u32 s59, s56, s57
s_and_b32 s57, s42, 3
s_lshl_b32 s57, s57, 8
s_add_u32 s59, s59, s57
s_waitcnt vmcnt(15)
v_mfma_f32_32x32x16_bf16 v[96:111], a[216:219], v[176:179], 0
s_waitcnt vmcnt(14)
v_mfma_f32_32x32x16_bf16 v[96:111], a[216:219], v[180:183], v[96:111]
s_waitcnt vmcnt(13)
v_mfma_f32_32x32x16_bf16 v[96:111], a[216:219], v[184:187], v[96:111]
s_waitcnt vmcnt(12)
v_mfma_f32_32x32x16_bf16 v[96:111], a[216:219], v[188:191], v[96:111]
s_waitcnt vmcnt(11)
v_mfma_f32_32x32x16_bf16 v[96:111], a[216:219], v[192:195], v[96:111]
s_waitcnt vmcnt(10)
v_mfma_f32_32x32x16_bf16 v[96:111], a[216:219], v[196:199], v[96:111]
s_waitcnt vmcnt(9)
v_mfma_f32_32x32x16_bf16 v[96:111], a[216:219], v[200:203], v[96:111]
s_waitcnt vmcnt(8)
v_mfma_f32_32x32x16_bf16 v[96:111], a[216:219], v[204:207], v[96:111]
s_waitcnt vmcnt(7)
v_mfma_f32_32x32x16_bf16 v[96:111], a[216:219], v[208:211], v[96:111]
s_waitcnt vmcnt(6)
v_mfma_f32_32x32x16_bf16 v[96:111], a[216:219], v[212:215], v[96:111]
s_waitcnt vmcnt(5)
v_mfma_f32_32x32x16_bf16 v[96:111], a[216:219], v[216:219], v[96:111]
s_waitcnt vmcnt(4)
v_mfma_f32_32x32x16_bf16 v[96:111], a[216:219], v[220:223], v[96:111]
s_waitcnt vmcnt(3)
v_mfma_f32_32x32x16_bf16 v[96:111], a[216:219], v[224:227], v[96:111]
s_waitcnt vmcnt(2)
v_mfma_f32_32x32x16_bf16 v[96:111], a[216:219], v[228:231], v[96:111]
s_waitcnt vmcnt(1)
v_mfma_f32_32x32x16_bf16 v[96:111], a[216:219], v[232:235], v[96:111]
s_waitcnt vmcnt(0)
v_mfma_f32_32x32x16_bf16 v[96:111], a[216:219], v[236:239], v[96:111]
s_nop 11
v_cvt_pk_bf16_f32 v96, v96, v97
v_cvt_pk_bf16_f32 v97, v98, v99
ds_write_b64 v172, v[96:97]
v_cvt_pk_bf16_f32 v100, v100, v101
v_cvt_pk_bf16_f32 v101, v102, v103
ds_write_b64 v173, v[100:101]
s_waitcnt lgkmcnt(0)
s_barrier
ds_read_b128 v[176:179], v170 offset:0
ds_read_b128 v[196:199], v171 offset:0
ds_read_b128 v[180:183], v170 offset:16
ds_read_b128 v[200:203], v171 offset:16
ds_read_b128 v[184:187], v170 offset:32
ds_read_b128 v[204:207], v171 offset:32
ds_read_b128 v[188:191], v170 offset:48
ds_read_b128 v[208:211], v171 offset:48
ds_read_b128 v[192:195], v170 offset:64
ds_read_b128 v[212:215], v171 offset:64
s_waitcnt lgkmcnt(8)
v_mfma_f32_32x32x16_bf16 v[64:79], v[176:179], v[36:39], 0
v_mfma_f32_32x32x16_bf16 v[80:95], v[196:199], v[36:39], 0
s_waitcnt lgkmcnt(6)
v_mfma_f32_32x32x16_bf16 v[64:79], v[180:183], v[40:43], v[64:79]
v_mfma_f32_32x32x16_bf16 v[80:95], v[200:203], v[40:43], v[80:95]
s_waitcnt lgkmcnt(4)
v_mfma_f32_32x32x16_bf16 v[64:79], v[184:187], v[44:47], v[64:79]
v_mfma_f32_32x32x16_bf16 v[80:95], v[204:207], v[44:47], v[80:95]
s_waitcnt lgkmcnt(2)
v_mfma_f32_32x32x16_bf16 v[64:79], v[188:191], v[48:51], v[64:79]
v_mfma_f32_32x32x16_bf16 v[80:95], v[208:211], v[48:51], v[80:95]
s_waitcnt lgkmcnt(0)
v_mfma_f32_32x32x16_bf16 v[64:79], v[192:195], v[52:55], v[64:79]
v_mfma_f32_32x32x16_bf16 v[80:95], v[212:215], v[52:55], v[80:95]
s_mov_b32 s91, 897988541
s_nop 10
v_add_f32 v84, s91, v84
v_rcp_f32 v84, v84
s_nop 0
v_pk_mul_f32 v[64:65], v[64:65], v[84:85] op_sel_hi:[1,0]
v_pk_mul_f32 v[66:67], v[66:67], v[84:85] op_sel_hi:[1,0]
v_pk_mul_f32 v[68:69], v[68:69], v[84:85] op_sel_hi:[1,0]
v_pk_mul_f32 v[70:71], v[70:71], v[84:85] op_sel_hi:[1,0]
v_pk_mul_f32 v[72:73], v[72:73], v[84:85] op_sel_hi:[1,0]
v_pk_mul_f32 v[74:75], v[74:75], v[84:85] op_sel_hi:[1,0]
v_pk_mul_f32 v[76:77], v[76:77], v[84:85] op_sel_hi:[1,0]
v_pk_mul_f32 v[78:79], v[78:79], v[84:85] op_sel_hi:[1,0]
v_pk_mul_f32 v[80:81], v[80:81], v[84:85] op_sel_hi:[1,0]
v_pk_mul_f32 v[82:83], v[82:83], v[84:85] op_sel_hi:[1,0]
v_cvt_pk_bf16_f32 v176, v64, v65
v_cvt_pk_bf16_f32 v177, v66, v67
v_cvt_pk_bf16_f32 v178, v68, v69
v_cvt_pk_bf16_f32 v179, v70, v71
v_cvt_pk_bf16_f32 v180, v72, v73
v_cvt_pk_bf16_f32 v181, v74, v75
v_cvt_pk_bf16_f32 v182, v76, v77
v_cvt_pk_bf16_f32 v183, v78, v79
v_cvt_pk_bf16_f32 v184, v80, v81
v_cvt_pk_bf16_f32 v185, v82, v83
s_cmp_eq_u32 s10, 1
s_nop 3
s_cbranch_scc1 Lst_35
buffer_store_dwordx4 v[176:179], v174, s[32:35], s58 offen sc1
buffer_store_dwordx4 v[180:183], v174, s[32:35], s58 offen offset:256 sc1
buffer_store_dwordx2 v[184:185], v175, s[32:35], s59 offen sc1
s_nop 0
s_branch Lst_36
Lst_35:
buffer_store_dwordx4 v[176:179], v174, s[32:35], s58 offen
buffer_store_dwordx4 v[180:183], v174, s[32:35], s58 offen offset:256
buffer_store_dwordx2 v[184:185], v175, s[32:35], s59 offen
s_nop 0
Lst_36:
s_waitcnt vmcnt(0)
s_cmp_eq_u32 s83, 1
s_cbranch_scc0 Larr_38
s_lshr_b32 s91, s87, 4
s_add_u32 s91, s91, 2
s_mov_b64 exec, 1
v_mov_b32 v168, s3
v_mov_b32 v169, s91
global_store_dword v168, v169, s[30:31]
s_mov_b64 exec, -1
s_nop 2
s_branch Larr_37
Larr_38:
s_barrier
s_cmp_eq_u32 s40, 0
s_cbranch_scc0 Larr_37
s_mov_b64 exec, 1
v_mov_b32 v168, s84
global_atomic_add v168, v11, s[30:31] sc1
s_mov_b64 exec, -1
s_nop 2
Larr_37:
s_lshr_b32 s91, s87, 4
s_add_u32 s91, s91, 2
s_cmp_eq_u32 s83, 1
s_cbranch_scc1 Lpf_39
s_cmp_eq_u32 s40, 1
s_cbranch_scc0 Lps_41
s_lshl_b32 s91, s91, 4
v_mov_b32 v168, s84
v_mov_b32 v169, s91
v_mov_b32 v171, 0xff
s_mov_b64 exec, 1
s_cmp_eq_u32 s53, 0
s_cselect_b32 s82, 0, 6000000
s_nop 1
Lp_42:
global_load_dword v170, v168, s[30:31] sc1
s_add_u32 s82, s82, 1
s_cmp_gt_u32 s82, 6000000
s_cbranch_scc1 Lpd_43_to
s_waitcnt vmcnt(0)
v_and_b32 v172, v171, v170
v_cmp_lt_u32 vcc, v172, v169
s_nop 4
s_cbranch_vccz Lpd_43
s_branch Lp_42
Lpd_43_to:
s_or_b32 s53, s53, 16
s_waitcnt vmcnt(0)
Lpd_43:
s_mov_b64 exec, -1
Lps_41:
s_barrier
s_branch Lpg_40
Lpf_39:
s_lshl_b32 s79, s41, 8
s_add_u32 s79, s79, 16384
v_lshlrev_b32 v168, 2, v1
v_add_u32 v168, s79, v168
v_mov_b32 v169, s91
v_mov_b32 v171, -1
s_cmp_eq_u32 s53, 0
s_cselect_b32 s82, 0, 6000000
s_nop 2
Lp_44:
global_load_dword v170, v168, s[30:31] sc1
s_add_u32 s82, s82, 1
s_cmp_gt_u32 s82, 6000000
s_cbranch_scc1 Lpd_45_to
s_waitcnt vmcnt(0)
v_and_b32 v172, v171, v170
v_cmp_lt_u32 vcc, v172, v169
s_nop 4
s_cbranch_vccz Lpd_45
s_branch Lp_44
Lpd_45_to:
s_or_b32 s53, s53, 16
s_waitcnt vmcnt(0)
Lpd_45:
Lpg_40:
s_lshl_b32 s56, s8, 22
s_add_u32 s56, s56, 33554432
s_mul_i32 s57, s41, 163840
s_add_u32 s56, s56, s57
s_lshl_b32 s57, s43, 1
s_add_u32 s57, s57, s45
s_mul_i32 s57, s57, 40960
s_add_u32 s56, s56, s57
s_mul_i32 s57, s46, 10240
s_add_u32 s56, s56, s57
s_add_u32 s57, s56, 20480
buffer_load_dwordx4 a[0:3], v6, s[32:35], s56 offen sc1
buffer_load_dwordx4 a[40:43], v6, s[32:35], s57 offen sc1
buffer_load_dwordx4 a[4:7], v6, s[32:35], s56 offen offset:1024 sc1
buffer_load_dwordx4 a[44:47], v6, s[32:35], s57 offen offset:1024 sc1
buffer_load_dwordx4 a[8:11], v6, s[32:35], s56 offen offset:2048 sc1
buffer_load_dwordx4 a[48:51], v6, s[32:35], s57 offen offset:2048 sc1
buffer_load_dwordx4 a[12:15], v6, s[32:35], s56 offen offset:3072 sc1
buffer_load_dwordx4 a[52:55], v6, s[32:35], s57 offen offset:3072 sc1
s_add_u32 s56, s56, 4096
buffer_load_dwordx4 a[16:19], v6, s[32:35], s56 offen sc1
s_add_u32 s57, s57, 4096
buffer_load_dwordx4 a[56:59], v6, s[32:35], s57 offen sc1
s_mul_i32 s58, s46, 5120
s_add_u32 s58, s58, 102400
v_add_u32 v56, s58, v6
s_waitcnt vmcnt(8)
s_barrier
ds_read_b128 v[128:131], v56 offset:0
ds_read_b128 v[132:135], v56 offset:1024
ds_read_b128 v[136:139], v56 offset:2048
ds_read_b128 v[140:143], v56 offset:3072
ds_read_b128 v[144:147], v56 offset:4096
ds_read_b128 v[148:151], v56 offset:10240
ds_read_b128 v[152:155], v56 offset:11264
ds_read_b128 v[156:159], v56 offset:12288
ds_read_b128 v[160:163], v56 offset:13312
ds_read_b128 v[164:167], v56 offset:14336
s_waitcnt lgkmcnt(9)
v_mfma_f32_16x16x32_bf16 v[64:67], v[128:131], a[0:3], 0
v_mfma_f32_16x16x32_bf16 v[68:71], v[128:131], a[40:43], 0
buffer_load_dwordx4 a[20:23], v6, s[32:35], s56 offen offset:1024 sc1
s_waitcnt lgkmcnt(8)
v_mfma_f32_16x16x32_bf16 v[72:75], v[132:135], a[0:3], 0
v_mfma_f32_16x16x32_bf16 v[76:79], v[132:135], a[40:43], 0
buffer_load_dwordx4 a[60:63], v6, s[32:35], s57 offen offset:1024 sc1
s_waitcnt lgkmcnt(7)
v_mfma_f32_16x16x32_bf16 v[80:83], v[136:139], a[0:3], 0
v_mfma_f32_16x16x32_bf16 v[84:87], v[136:139], a[40:43], 0
buffer_load_dwordx4 a[24:27], v6, s[32:35], s56 offen offset:2048 sc1
s_waitcnt lgkmcnt(6)
v_mfma_f32_16x16x32_bf16 v[88:91], v[140:143], a[0:3], 0
v_mfma_f32_16x16x32_bf16 v[92:95], v[140:143], a[40:43], 0
s_waitcnt lgkmcnt(5)
v_mfma_f32_16x16x32_bf16 v[96:99], v[144:147], a[0:3], 0
v_mfma_f32_16x16x32_bf16 v[100:103], v[144:147], a[40:43], 0
ds_read_b128 v[128:131], v56 offset:20480
ds_read_b128 v[132:135], v56 offset:21504
ds_read_b128 v[136:139], v56 offset:22528
ds_read_b128 v[140:143], v56 offset:23552
ds_read_b128 v[144:147], v56 offset:24576
s_waitcnt vmcnt(9)
s_waitcnt lgkmcnt(9)
v_mfma_f32_16x16x32_bf16 v[64:67], v[148:151], a[4:7], v[64:67]
v_mfma_f32_16x16x32_bf16 v[68:71], v[148:151], a[44:47], v[68:71]
buffer_load_dwordx4 a[64:67], v6, s[32:35], s57 offen offset:2048 sc1
s_waitcnt lgkmcnt(8)
v_mfma_f32_16x16x32_bf16 v[72:75], v[152:155], a[4:7], v[72:75]
v_mfma_f32_16x16x32_bf16 v[76:79], v[152:155], a[44:47], v[76:79]
s_waitcnt lgkmcnt(7)
v_mfma_f32_16x16x32_bf16 v[80:83], v[156:159], a[4:7], v[80:83]
v_mfma_f32_16x16x32_bf16 v[84:87], v[156:159], a[44:47], v[84:87]
buffer_load_dwordx4 a[28:31], v6, s[32:35], s56 offen offset:3072 sc1
s_waitcnt lgkmcnt(6)
v_mfma_f32_16x16x32_bf16 v[88:91], v[160:163], a[4:7], v[88:91]
v_mfma_f32_16x16x32_bf16 v[92:95], v[160:163], a[44:47], v[92:95]
s_waitcnt lgkmcnt(5)
v_mfma_f32_16x16x32_bf16 v[96:99], v[164:167], a[4:7], v[96:99]
v_mfma_f32_16x16x32_bf16 v[100:103], v[164:167], a[44:47], v[100:103]
ds_read_b128 v[148:151], v56 offset:30720
ds_read_b128 v[152:155], v56 offset:31744
ds_read_b128 v[156:159], v56 offset:32768
ds_read_b128 v[160:163], v56 offset:33792
ds_read_b128 v[164:167], v56 offset:34816
s_waitcnt vmcnt(9)
s_waitcnt lgkmcnt(9)
v_mfma_f32_16x16x32_bf16 v[64:67], v[128:131], a[8:11], v[64:67]
v_mfma_f32_16x16x32_bf16 v[68:71], v[128:131], a[48:51], v[68:71]
buffer_load_dwordx4 a[68:71], v6, s[32:35], s57 offen offset:3072 sc1
s_waitcnt lgkmcnt(8)
v_mfma_f32_16x16x32_bf16 v[72:75], v[132:135], a[8:11], v[72:75]
v_mfma_f32_16x16x32_bf16 v[76:79], v[132:135], a[48:51], v[76:79]
s_waitcnt lgkmcnt(7)
v_mfma_f32_16x16x32_bf16 v[80:83], v[136:139], a[8:11], v[80:83]
v_mfma_f32_16x16x32_bf16 v[84:87], v[136:139], a[48:51], v[84:87]
s_add_u32 s56, s56, 4096
buffer_load_dwordx4 a[32:35], v6, s[32:35], s56 offen sc1
s_waitcnt lgkmcnt(6)
v_mfma_f32_16x16x32_bf16 v[88:91], v[140:143], a[8:11], v[88:91]
v_mfma_f32_16x16x32_bf16 v[92:95], v[140:143], a[48:51], v[92:95]
s_waitcnt lgkmcnt(5)
v_mfma_f32_16x16x32_bf16 v[96:99], v[144:147], a[8:11], v[96:99]
v_mfma_f32_16x16x32_bf16 v[100:103], v[144:147], a[48:51], v[100:103]
v_add_u32 v56, -71680, v56
ds_read_b128 v[128:131], v56 offset:0
ds_read_b128 v[132:135], v56 offset:1024
ds_read_b128 v[136:139], v56 offset:2048
ds_read_b128 v[140:143], v56 offset:3072
ds_read_b128 v[144:147], v56 offset:4096
s_waitcnt vmcnt(9)
s_waitcnt lgkmcnt(9)
v_mfma_f32_16x16x32_bf16 v[64:67], v[148:151], a[12:15], v[64:67]
v_mfma_f32_16x16x32_bf16 v[68:71], v[148:151], a[52:55], v[68:71]
s_add_u32 s57, s57, 4096
buffer_load_dwordx4 a[72:75], v6, s[32:35], s57 offen sc1
s_waitcnt lgkmcnt(8)
v_mfma_f32_16x16x32_bf16 v[72:75], v[152:155], a[12:15], v[72:75]
v_mfma_f32_16x16x32_bf16 v[76:79], v[152:155], a[52:55], v[76:79]
s_waitcnt lgkmcnt(7)
v_mfma_f32_16x16x32_bf16 v[80:83], v[156:159], a[12:15], v[80:83]
v_mfma_f32_16x16x32_bf16 v[84:87], v[156:159], a[52:55], v[84:87]
buffer_load_dwordx4 a[36:39], v6, s[32:35], s56 offen offset:1024 sc1
s_waitcnt lgkmcnt(6)
v_mfma_f32_16x16x32_bf16 v[88:91], v[160:163], a[12:15], v[88:91]
v_mfma_f32_16x16x32_bf16 v[92:95], v[160:163], a[52:55], v[92:95]
s_waitcnt lgkmcnt(5)
v_mfma_f32_16x16x32_bf16 v[96:99], v[164:167], a[12:15], v[96:99]
v_mfma_f32_16x16x32_bf16 v[100:103], v[164:167], a[52:55], v[100:103]
ds_read_b128 v[148:151], v56 offset:10240
ds_read_b128 v[152:155], v56 offset:11264
ds_read_b128 v[156:159], v56 offset:12288
ds_read_b128 v[160:163], v56 offset:13312
ds_read_b128 v[164:167], v56 offset:14336
s_barrier
s_waitcnt vmcnt(9)
s_waitcnt lgkmcnt(9)
v_mfma_f32_16x16x32_bf16 v[64:67], v[128:131], a[16:19], v[64:67]
v_mfma_f32_16x16x32_bf16 v[68:71], v[128:131], a[56:59], v[68:71]
buffer_load_dwordx4 a[76:79], v6, s[32:35], s57 offen offset:1024 sc1
s_waitcnt lgkmcnt(8)
v_mfma_f32_16x16x32_bf16 v[72:75], v[132:135], a[16:19], v[72:75]
v_mfma_f32_16x16x32_bf16 v[76:79], v[132:135], a[56:59], v[76:79]
s_add_u32 m0, s4, 102400
s_add_u32 s5, s66, 27648
buffer_load_dwordx4 v6, s[32:35], s5 offen sc1 lds
s_waitcnt lgkmcnt(7)
v_mfma_f32_16x16x32_bf16 v[80:83], v[136:139], a[16:19], v[80:83]
v_mfma_f32_16x16x32_bf16 v[84:87], v[136:139], a[56:59], v[84:87]
s_waitcnt lgkmcnt(6)
v_mfma_f32_16x16x32_bf16 v[88:91], v[140:143], a[16:19], v[88:91]
v_mfma_f32_16x16x32_bf16 v[92:95], v[140:143], a[56:59], v[92:95]
s_add_u32 m0, s4, 106496
s_add_u32 s5, s66, 31744
buffer_load_dwordx4 v6, s[32:35], s5 offen sc1 lds
s_waitcnt lgkmcnt(5)
v_mfma_f32_16x16x32_bf16 v[96:99], v[144:147], a[16:19], v[96:99]
v_mfma_f32_16x16x32_bf16 v[100:103], v[144:147], a[56:59], v[100:103]
s_add_u32 m0, s4, 110592
s_add_u32 s5, s66, 35840
buffer_load_dwordx4 v6, s[32:35], s5 offen sc1 lds
ds_read_b128 v[128:131], v56 offset:20480
ds_read_b128 v[132:135], v56 offset:21504
ds_read_b128 v[136:139], v56 offset:22528
ds_read_b128 v[140:143], v56 offset:23552
ds_read_b128 v[144:147], v56 offset:24576
s_waitcnt vmcnt(11)
s_waitcnt lgkmcnt(9)
v_mfma_f32_16x16x32_bf16 v[64:67], v[148:151], a[20:23], v[64:67]
v_mfma_f32_16x16x32_bf16 v[68:71], v[148:151], a[60:63], v[68:71]
s_waitcnt lgkmcnt(8)
v_mfma_f32_16x16x32_bf16 v[72:75], v[152:155], a[20:23], v[72:75]
v_mfma_f32_16x16x32_bf16 v[76:79], v[152:155], a[60:63], v[76:79]
s_add_u32 m0, s4, 114688
s_add_u32 s5, s66, 39936
buffer_load_dwordx4 v6, s[32:35], s5 offen sc1 lds
s_waitcnt lgkmcnt(7)
v_mfma_f32_16x16x32_bf16 v[80:83], v[156:159], a[20:23], v[80:83]
v_mfma_f32_16x16x32_bf16 v[84:87], v[156:159], a[60:63], v[84:87]
s_waitcnt lgkmcnt(6)
v_mfma_f32_16x16x32_bf16 v[88:91], v[160:163], a[20:23], v[88:91]
v_mfma_f32_16x16x32_bf16 v[92:95], v[160:163], a[60:63], v[92:95]
s_add_u32 m0, s4, 118784
s_add_u32 s5, s66, 44032
buffer_load_dwordx4 v6, s[32:35], s5 offen sc1 lds
s_waitcnt lgkmcnt(5)
v_mfma_f32_16x16x32_bf16 v[96:99], v[164:167], a[20:23], v[96:99]
v_mfma_f32_16x16x32_bf16 v[100:103], v[164:167], a[60:63], v[100:103]
s_add_u32 m0, s4, 122880
s_add_u32 s5, s66, 48128
buffer_load_dwordx4 v6, s[32:35], s5 offen sc1 lds
ds_read_b128 v[148:151], v56 offset:30720
ds_read_b128 v[152:155], v56 offset:31744
ds_read_b128 v[156:159], v56 offset:32768
ds_read_b128 v[160:163], v56 offset:33792
ds_read_b128 v[164:167], v56 offset:34816
s_waitcnt vmcnt(12)
s_waitcnt lgkmcnt(9)
v_mfma_f32_16x16x32_bf16 v[64:67], v[128:131], a[24:27], v[64:67]
v_mfma_f32_16x16x32_bf16 v[68:71], v[128:131], a[64:67], v[68:71]
s_waitcnt lgkmcnt(8)
v_mfma_f32_16x16x32_bf16 v[72:75], v[132:135], a[24:27], v[72:75]
v_mfma_f32_16x16x32_bf16 v[76:79], v[132:135], a[64:67], v[76:79]
s_add_u32 m0, s4, 126976
s_add_u32 s5, s66, 52224
buffer_load_dwordx4 v6, s[32:35], s5 offen sc1 lds
s_waitcnt lgkmcnt(7)
v_mfma_f32_16x16x32_bf16 v[80:83], v[136:139], a[24:27], v[80:83]
v_mfma_f32_16x16x32_bf16 v[84:87], v[136:139], a[64:67], v[84:87]
s_waitcnt lgkmcnt(6)
v_mfma_f32_16x16x32_bf16 v[88:91], v[140:143], a[24:27], v[88:91]
v_mfma_f32_16x16x32_bf16 v[92:95], v[140:143], a[64:67], v[92:95]
s_add_u32 m0, s4, 131072
s_add_u32 s5, s66, 56320
buffer_load_dwordx4 v6, s[32:35], s5 offen sc1 lds
s_waitcnt lgkmcnt(5)
v_mfma_f32_16x16x32_bf16 v[96:99], v[144:147], a[24:27], v[96:99]
v_mfma_f32_16x16x32_bf16 v[100:103], v[144:147], a[64:67], v[100:103]
s_add_u32 m0, s4, 135168
s_add_u32 s5, s66, 60416
buffer_load_dwordx4 v6, s[32:35], s5 offen sc1 lds
ds_read_b128 v[128:131], v56 offset:40960
ds_read_b128 v[132:135], v56 offset:41984
ds_read_b128 v[136:139], v56 offset:43008
ds_read_b128 v[140:143], v56 offset:44032
ds_read_b128 v[144:147], v56 offset:45056
s_waitcnt vmcnt(13)
s_waitcnt lgkmcnt(9)
v_mfma_f32_16x16x32_bf16 v[64:67], v[148:151], a[28:31], v[64:67]
v_mfma_f32_16x16x32_bf16 v[68:71], v[148:151], a[68:71], v[68:71]
s_waitcnt lgkmcnt(8)
v_mfma_f32_16x16x32_bf16 v[72:75], v[152:155], a[28:31], v[72:75]
v_mfma_f32_16x16x32_bf16 v[76:79], v[152:155], a[68:71], v[76:79]
s_mov_b32 m0, 0x30000
s_mov_b32 s5, 64512
s_sub_u32 s6, s40, 0
s_cmp_lt_u32 s6, 3
s_cselect_b32 s5, 64512, s5
s_add_u32 s6, s4, 139264
s_sub_u32 s7, s40, 0
s_cmp_lt_u32 s7, 3
s_cselect_b32 m0, s6, m0
s_add_u32 s5, s5, s66
buffer_load_dwordx4 v6, s[32:35], s5 offen sc1 lds
s_waitcnt lgkmcnt(7)
v_mfma_f32_16x16x32_bf16 v[80:83], v[156:159], a[28:31], v[80:83]
v_mfma_f32_16x16x32_bf16 v[84:87], v[156:159], a[68:71], v[84:87]
s_waitcnt lgkmcnt(6)
v_mfma_f32_16x16x32_bf16 v[88:91], v[160:163], a[28:31], v[88:91]
v_mfma_f32_16x16x32_bf16 v[92:95], v[160:163], a[68:71], v[92:95]
s_waitcnt lgkmcnt(5)
v_mfma_f32_16x16x32_bf16 v[96:99], v[164:167], a[28:31], v[96:99]
v_mfma_f32_16x16x32_bf16 v[100:103], v[164:167], a[68:71], v[100:103]
ds_read_b128 v[148:151], v56 offset:51200
ds_read_b128 v[152:155], v56 offset:52224
ds_read_b128 v[156:159], v56 offset:53248
ds_read_b128 v[160:163], v56 offset:54272
ds_read_b128 v[164:167], v56 offset:55296
s_waitcnt vmcnt(12)
s_waitcnt lgkmcnt(9)
v_mfma_f32_16x16x32_bf16 v[64:67], v[128:131], a[32:35], v[64:67]
v_mfma_f32_16x16x32_bf16 v[68:71], v[128:131], a[72:75], v[68:71]
s_waitcnt lgkmcnt(8)
v_mfma_f32_16x16x32_bf16 v[72:75], v[132:135], a[32:35], v[72:75]
v_mfma_f32_16x16x32_bf16 v[76:79], v[132:135], a[72:75], v[76:79]
s_waitcnt lgkmcnt(7)
v_mfma_f32_16x16x32_bf16 v[80:83], v[136:139], a[32:35], v[80:83]
v_mfma_f32_16x16x32_bf16 v[84:87], v[136:139], a[72:75], v[84:87]
s_waitcnt lgkmcnt(6)
v_mfma_f32_16x16x32_bf16 v[88:91], v[140:143], a[32:35], v[88:91]
v_mfma_f32_16x16x32_bf16 v[92:95], v[140:143], a[72:75], v[92:95]
s_waitcnt lgkmcnt(5)
v_mfma_f32_16x16x32_bf16 v[96:99], v[144:147], a[32:35], v[96:99]
v_mfma_f32_16x16x32_bf16 v[100:103], v[144:147], a[72:75], v[100:103]
s_waitcnt vmcnt(10)
s_waitcnt lgkmcnt(4)
v_mfma_f32_16x16x32_bf16 v[64:67], v[148:151], a[36:39], v[64:67]
v_mfma_f32_16x16x32_bf16 v[68:71], v[148:151], a[76:79], v[68:71]
s_waitcnt lgkmcnt(3)
v_mfma_f32_16x16x32_bf16 v[72:75], v[152:155], a[36:39], v[72:75]
v_mfma_f32_16x16x32_bf16 v[76:79], v[152:155], a[76:79], v[76:79]
s_waitcnt lgkmcnt(2)
v_mfma_f32_16x16x32_bf16 v[80:83], v[156:159], a[36:39], v[80:83]
v_mfma_f32_16x16x32_bf16 v[84:87], v[156:159], a[76:79], v[84:87]
s_waitcnt lgkmcnt(1)
v_mfma_f32_16x16x32_bf16 v[88:91], v[160:163], a[36:39], v[88:91]
v_mfma_f32_16x16x32_bf16 v[92:95], v[160:163], a[76:79], v[92:95]
s_waitcnt lgkmcnt(0)
v_mfma_f32_16x16x32_bf16 v[96:99], v[164:167], a[36:39], v[96:99]
v_mfma_f32_16x16x32_bf16 v[100:103], v[164:167], a[76:79], v[100:103]
s_mul_i32 s56, s40, 5120
s_add_u32 s56, s56, 143360
v_add_u32 v168, s56, v6
s_xor_b32 s57, s40, 2
s_mul_i32 s57, s57, 5120
s_add_u32 s57, s57, 143360
v_add_u32 v169, s57, v6
s_cmp_eq_u32 s46, 0
s_nop 3
s_cbranch_scc0 Lrk_46
ds_write_b128 v168, v[68:71] offset:0
ds_write_b128 v168, v[76:79] offset:1024
ds_write_b128 v168, v[84:87] offset:2048
ds_write_b128 v168, v[92:95] offset:3072
ds_write_b128 v168, v[100:103] offset:4096
v_pk_add_f32 v[16:17], v[16:17], v[64:65]
v_pk_add_f32 v[18:19], v[18:19], v[66:67]
v_pk_add_f32 v[20:21], v[20:21], v[72:73]
v_pk_add_f32 v[22:23], v[22:23], v[74:75]
v_pk_add_f32 v[24:25], v[24:25], v[80:81]
v_pk_add_f32 v[26:27], v[26:27], v[82:83]
v_pk_add_f32 v[28:29], v[28:29], v[88:89]
v_pk_add_f32 v[30:31], v[30:31], v[90:91]
v_pk_add_f32 v[32:33], v[32:33], v[96:97]
v_pk_add_f32 v[34:35], v[34:35], v[98:99]
s_nop 4
s_branch Lrk_47
Lrk_46:
ds_write_b128 v168, v[64:67] offset:0
ds_write_b128 v168, v[72:75] offset:1024
ds_write_b128 v168, v[80:83] offset:2048
ds_write_b128 v168, v[88:91] offset:3072
ds_write_b128 v168, v[96:99] offset:4096
v_pk_add_f32 v[16:17], v[16:17], v[68:69]
v_pk_add_f32 v[18:19], v[18:19], v[70:71]
v_pk_add_f32 v[20:21], v[20:21], v[76:77]
v_pk_add_f32 v[22:23], v[22:23], v[78:79]
v_pk_add_f32 v[24:25], v[24:25], v[84:85]
v_pk_add_f32 v[26:27], v[26:27], v[86:87]
v_pk_add_f32 v[28:29], v[28:29], v[92:93]
v_pk_add_f32 v[30:31], v[30:31], v[94:95]
v_pk_add_f32 v[32:33], v[32:33], v[100:101]
v_pk_add_f32 v[34:35], v[34:35], v[102:103]
s_nop 4
Lrk_47:
s_waitcnt lgkmcnt(0)
s_barrier
ds_read_b128 v[176:179], v169 offset:0
ds_read_b128 v[180:183], v169 offset:1024
ds_read_b128 v[184:187], v169 offset:2048
ds_read_b128 v[188:191], v169 offset:3072
ds_read_b128 v[192:195], v169 offset:4096
s_waitcnt lgkmcnt(4)
v_pk_add_f32 v[16:17], v[16:17], v[176:177]
v_pk_add_f32 v[18:19], v[18:19], v[178:179]
s_waitcnt lgkmcnt(3)
v_pk_add_f32 v[20:21], v[20:21], v[180:181]
v_pk_add_f32 v[22:23], v[22:23], v[182:183]
s_waitcnt lgkmcnt(2)
v_pk_add_f32 v[24:25], v[24:25], v[184:185]
v_pk_add_f32 v[26:27], v[26:27], v[186:187]
s_waitcnt lgkmcnt(1)
v_pk_add_f32 v[28:29], v[28:29], v[188:189]
v_pk_add_f32 v[30:31], v[30:31], v[190:191]
s_waitcnt lgkmcnt(0)
v_pk_add_f32 v[32:33], v[32:33], v[192:193]
v_pk_add_f32 v[34:35], v[34:35], v[194:195]
s_lshl_b32 s62, s8, 23
s_add_u32 s62, s62, 16777216
s_add_u32 s62, s62, s9
s_add_u32 s62, s62, s48
s_lshl_b32 s63, s47, 18
s_add_u32 s63, s63, 3276800
s_add_u32 s63, s63, s49
v_cvt_pk_bf16_f32 v176, v20, v21
v_cvt_pk_bf16_f32 v177, v22, v23
v_cvt_pk_bf16_f32 v178, v16, v17
v_cvt_pk_bf16_f32 v179, v18, v19
v_cvt_pk_bf16_f32 v180, v28, v29
v_cvt_pk_bf16_f32 v181, v30, v31
v_cvt_pk_bf16_f32 v182, v24, v25
v_cvt_pk_bf16_f32 v183, v26, v27
v_cvt_pk_bf16_f32 v184, v32, v33
v_cvt_pk_bf16_f32 v185, v34, v35
v_permlane16_swap_b32 v176, v178
v_permlane16_swap_b32 v177, v179
v_permlane16_swap_b32 v180, v182
v_permlane16_swap_b32 v181, v183
s_cmp_eq_u32 s83, 1
s_nop 3
s_cbranch_scc1 Lst_48
buffer_store_dwordx4 v[176:179], v7, s[32:35], s62 offen sc1
buffer_store_dwordx4 v[180:183], v7, s[32:35], s62 offen offset:2048 sc1
buffer_store_dwordx2 v[184:185], v8, s[32:35], s62 offen sc1
s_nop 0
s_branch Lst_49
Lst_48:
buffer_store_dwordx4 v[176:179], v7, s[32:35], s62 offen
buffer_store_dwordx4 v[180:183], v7, s[32:35], s62 offen offset:2048
buffer_store_dwordx2 v[184:185], v8, s[32:35], s62 offen
s_nop 0
Lst_49:
v_pk_add_f32 v[186:187], v[16:17], v[18:19]
v_pk_mul_f32 v[188:189], v[16:17], v[16:17]
v_pk_fma_f32 v[188:189], v[18:19], v[18:19], v[188:189]
v_pk_add_f32 v[186:187], v[186:187], v[20:21]
v_pk_fma_f32 v[188:189], v[20:21], v[20:21], v[188:189]
v_pk_add_f32 v[186:187], v[186:187], v[22:23]
v_pk_fma_f32 v[188:189], v[22:23], v[22:23], v[188:189]
v_pk_add_f32 v[186:187], v[186:187], v[24:25]
v_pk_fma_f32 v[188:189], v[24:25], v[24:25], v[188:189]
v_pk_add_f32 v[186:187], v[186:187], v[26:27]
v_pk_fma_f32 v[188:189], v[26:27], v[26:27], v[188:189]
v_pk_add_f32 v[186:187], v[186:187], v[28:29]
v_pk_fma_f32 v[188:189], v[28:29], v[28:29], v[188:189]
v_pk_add_f32 v[186:187], v[186:187], v[30:31]
v_pk_fma_f32 v[188:189], v[30:31], v[30:31], v[188:189]
v_pk_add_f32 v[186:187], v[186:187], v[32:33]
v_pk_fma_f32 v[188:189], v[32:33], v[32:33], v[188:189]
v_pk_add_f32 v[186:187], v[186:187], v[34:35]
v_pk_fma_f32 v[188:189], v[34:35], v[34:35], v[188:189]
v_add_f32 v186, v186, v187
v_add_f32 v187, v188, v189
v_mov_b32 v188, v186
v_mov_b32 v189, v187
s_nop 0
v_permlane16_swap_b32 v186, v188
v_permlane16_swap_b32 v187, v189
v_add_f32 v186, v186, v188
v_add_f32 v187, v187, v189
v_mov_b32 v188, v186
v_mov_b32 v189, v187
s_nop 0
v_permlane32_swap_b32 v186, v188
v_permlane32_swap_b32 v187, v189
v_add_f32 v186, v186, v188
v_add_f32 v187, v187, v189
buffer_store_dwordx2 v[186:187], v9, s[32:35], s63 offen sc1
s_waitcnt vmcnt(0)
s_cmp_eq_u32 s83, 1
s_nop 1
s_cbranch_scc0 Larr_51
s_lshr_b32 s91, s87, 4
s_add_u32 s91, s91, 3
s_mov_b64 exec, 1
v_mov_b32 v168, s3
v_mov_b32 v169, s91
global_store_dword v168, v169, s[30:31]
s_mov_b64 exec, -1
s_nop 2
s_branch Larr_50
Larr_51:
s_barrier
s_cmp_eq_u32 s40, 0
s_cbranch_scc0 Larr_50
s_mov_b64 exec, 1
v_mov_b32 v168, s84
global_atomic_add v168, v11, s[30:31] sc1
s_mov_b64 exec, -1
s_nop 2
Larr_50:
s_lshr_b32 s91, s87, 4
s_add_u32 s91, s91, 3
s_cmp_eq_u32 s83, 1
s_cbranch_scc1 Lpf_52
s_cmp_eq_u32 s40, 1
s_cbranch_scc0 Lps_54
s_lshl_b32 s91, s91, 4
v_mov_b32 v168, s84
v_mov_b32 v169, s91
v_mov_b32 v171, 0xff
s_mov_b64 exec, 1
s_cmp_eq_u32 s53, 0
s_cselect_b32 s82, 0, 6000000
s_nop 1
Lp_55:
global_load_dword v170, v168, s[30:31] sc1
s_add_u32 s82, s82, 1
s_cmp_gt_u32 s82, 6000000
s_cbranch_scc1 Lpd_56_to
s_waitcnt vmcnt(0)
v_and_b32 v172, v171, v170
v_cmp_lt_u32 vcc, v172, v169
s_nop 4
s_cbranch_vccz Lpd_56
s_branch Lp_55
Lpd_56_to:
s_or_b32 s53, s53, 32
s_waitcnt vmcnt(0)
Lpd_56:
s_mov_b64 exec, -1
Lps_54:
s_barrier
s_branch Lpg_53
Lpf_52:
s_lshl_b32 s79, s41, 8
s_add_u32 s79, s79, 16384
v_lshlrev_b32 v168, 2, v1
v_add_u32 v168, s79, v168
v_mov_b32 v169, s91
v_mov_b32 v171, -1
s_cmp_eq_u32 s53, 0
s_cselect_b32 s82, 0, 6000000
s_nop 2
Lp_57:
global_load_dword v170, v168, s[30:31] sc1
s_add_u32 s82, s82, 1
s_cmp_gt_u32 s82, 6000000
s_cbranch_scc1 Lpd_58_to
s_waitcnt vmcnt(0)
v_and_b32 v172, v171, v170
v_cmp_lt_u32 vcc, v172, v169
s_nop 4
s_cbranch_vccz Lpd_58
s_branch Lp_57
Lpd_58_to:
s_or_b32 s53, s53, 32
s_waitcnt vmcnt(0)
Lpd_58:
Lpg_53:
s_lshl_b32 s59, s42, 11
s_add_u32 s59, s59, 131072
v_lshlrev_b32 v242, 2, v0
s_lshl_b32 s60, s47, 18
s_add_u32 s60, s60, 3276800
s_lshl_b32 s61, s8, 23
s_add_u32 s61, s61, 16777216
s_add_u32 s61, s61, s9
s_mul_i32 s62, s41, 163840
s_add_u32 s61, s61, s62
s_mul_i32 s62, s40, 40960
s_add_u32 s61, s61, s62
buffer_load_dwordx4 a[0:3], v6, s[32:35], s61 offen sc1
buffer_load_dwordx4 a[4:7], v6, s[32:35], s61 offen offset:1024 sc1
buffer_load_dwordx4 a[8:11], v6, s[32:35], s61 offen offset:2048 sc1
buffer_load_dwordx4 a[12:15], v6, s[32:35], s61 offen offset:3072 sc1
s_add_u32 s61, s61, 4096
buffer_load_dwordx4 a[16:19], v6, s[32:35], s61 offen sc1
buffer_load_dwordx4 a[20:23], v6, s[32:35], s61 offen offset:1024 sc1
buffer_load_dwordx4 a[24:27], v6, s[32:35], s61 offen offset:2048 sc1
buffer_load_dwordx4 a[28:31], v6, s[32:35], s61 offen offset:3072 sc1
s_add_u32 s61, s61, 4096
buffer_load_dwordx4 a[32:35], v6, s[32:35], s61 offen sc1
buffer_load_dwordx4 a[36:39], v6, s[32:35], s61 offen offset:1024 sc1
v_add_u32 v56, 10240, v6
s_waitcnt vmcnt(9)
s_barrier
ds_read_b128 v[128:131], v56 offset:0
ds_read_b128 v[132:135], v56 offset:1024
ds_read_b128 v[136:139], v56 offset:2048
ds_read_b128 v[140:143], v56 offset:3072
ds_read_b128 v[144:147], v56 offset:4096
ds_read_b128 v[148:151], v56 offset:5120
ds_read_b128 v[152:155], v56 offset:6144
ds_read_b128 v[156:159], v56 offset:7168
s_waitcnt lgkmcnt(7)
v_mfma_f32_32x32x16_bf16 v[64:79], v[128:131], a[0:3], 0
buffer_load_dwordx4 a[40:43], v6, s[32:35], s61 offen offset:2048 sc1
ds_read_b128 v[160:163], v56 offset:8192
s_waitcnt lgkmcnt(7)
v_mfma_f32_32x32x16_bf16 v[80:95], v[132:135], a[0:3], 0
s_add_u32 m0, s4, 30720
s_add_u32 s5, s66, 67584
buffer_load_dwordx4 v6, s[32:35], s5 offen sc1 lds
ds_read_b128 v[164:167], v56 offset:9216
s_waitcnt lgkmcnt(7)
v_mfma_f32_32x32x16_bf16 v[96:111], v[136:139], a[0:3], 0
s_waitcnt vmcnt(10)
ds_read_b128 v[128:131], v56 offset:10240
s_waitcnt lgkmcnt(7)
v_mfma_f32_32x32x16_bf16 v[64:79], v[140:143], a[4:7], v[64:79]
buffer_load_dwordx4 a[44:47], v6, s[32:35], s61 offen offset:3072 sc1
ds_read_b128 v[132:135], v56 offset:11264
s_waitcnt lgkmcnt(7)
v_mfma_f32_32x32x16_bf16 v[80:95], v[144:147], a[4:7], v[80:95]
s_add_u32 m0, s4, 34816
s_add_u32 s5, s66, 71680
buffer_load_dwordx4 v6, s[32:35], s5 offen sc1 lds
ds_read_b128 v[136:139], v56 offset:12288
s_waitcnt lgkmcnt(7)
v_mfma_f32_32x32x16_bf16 v[96:111], v[148:151], a[4:7], v[96:111]
s_waitcnt vmcnt(11)
ds_read_b128 v[140:143], v56 offset:13312
s_waitcnt lgkmcnt(7)
v_mfma_f32_32x32x16_bf16 v[64:79], v[152:155], a[8:11], v[64:79]
s_add_u32 s61, s61, 4096
buffer_load_dwordx4 a[48:51], v6, s[32:35], s61 offen sc1
ds_read_b128 v[144:147], v56 offset:14336
s_waitcnt lgkmcnt(7)
v_mfma_f32_32x32x16_bf16 v[80:95], v[156:159], a[8:11], v[80:95]
s_add_u32 m0, s4, 38912
s_add_u32 s5, s66, 75776
buffer_load_dwordx4 v6, s[32:35], s5 offen sc1 lds
ds_read_b128 v[148:151], v56 offset:15360
s_waitcnt lgkmcnt(7)
v_mfma_f32_32x32x16_bf16 v[96:111], v[160:163], a[8:11], v[96:111]
s_waitcnt vmcnt(12)
ds_read_b128 v[152:155], v56 offset:16384
s_waitcnt lgkmcnt(7)
v_mfma_f32_32x32x16_bf16 v[64:79], v[164:167], a[12:15], v[64:79]
buffer_load_dwordx4 a[52:55], v6, s[32:35], s61 offen offset:1024 sc1
ds_read_b128 v[156:159], v56 offset:17408
s_waitcnt lgkmcnt(7)
v_mfma_f32_32x32x16_bf16 v[80:95], v[128:131], a[12:15], v[80:95]
s_add_u32 m0, s4, 43008
s_add_u32 s5, s66, 79872
buffer_load_dwordx4 v6, s[32:35], s5 offen sc1 lds
v_add_u32 v56, 81920, v56
ds_read_b128 v[160:163], v56 offset:0
s_waitcnt lgkmcnt(7)
v_mfma_f32_32x32x16_bf16 v[96:111], v[132:135], a[12:15], v[96:111]
s_waitcnt vmcnt(13)
ds_read_b128 v[164:167], v56 offset:1024
s_waitcnt lgkmcnt(7)
v_mfma_f32_32x32x16_bf16 v[64:79], v[136:139], a[16:19], v[64:79]
buffer_load_dwordx4 a[56:59], v6, s[32:35], s61 offen offset:2048 sc1
ds_read_b128 v[128:131], v56 offset:2048
s_waitcnt lgkmcnt(7)
v_mfma_f32_32x32x16_bf16 v[80:95], v[140:143], a[16:19], v[80:95]
s_add_u32 m0, s4, 47104
s_add_u32 s5, s66, 83968
buffer_load_dwordx4 v6, s[32:35], s5 offen sc1 lds
ds_read_b128 v[132:135], v56 offset:3072
s_waitcnt lgkmcnt(7)
v_mfma_f32_32x32x16_bf16 v[96:111], v[144:147], a[16:19], v[96:111]
s_waitcnt vmcnt(14)
ds_read_b128 v[136:139], v56 offset:4096
s_waitcnt lgkmcnt(7)
v_mfma_f32_32x32x16_bf16 v[64:79], v[148:151], a[20:23], v[64:79]
buffer_load_dwordx4 a[60:63], v6, s[32:35], s61 offen offset:3072 sc1
ds_read_b128 v[140:143], v56 offset:5120
s_waitcnt lgkmcnt(7)
v_mfma_f32_32x32x16_bf16 v[80:95], v[152:155], a[20:23], v[80:95]
s_add_u32 m0, s4, 51200
s_add_u32 s5, s66, 88064
buffer_load_dwordx4 v6, s[32:35], s5 offen sc1 lds
ds_read_b128 v[144:147], v56 offset:6144
s_waitcnt lgkmcnt(7)
v_mfma_f32_32x32x16_bf16 v[96:111], v[156:159], a[20:23], v[96:111]
s_waitcnt vmcnt(15)
ds_read_b128 v[148:151], v56 offset:7168
s_waitcnt lgkmcnt(7)
v_mfma_f32_32x32x16_bf16 v[64:79], v[160:163], a[24:27], v[64:79]
s_add_u32 s61, s61, 4096
buffer_load_dwordx4 a[64:67], v6, s[32:35], s61 offen sc1
ds_read_b128 v[152:155], v56 offset:8192
s_waitcnt lgkmcnt(7)
v_mfma_f32_32x32x16_bf16 v[80:95], v[164:167], a[24:27], v[80:95]
s_add_u32 m0, s4, 55296
s_add_u32 s5, s66, 92160
buffer_load_dwordx4 v6, s[32:35], s5 offen sc1 lds
ds_read_b128 v[156:159], v56 offset:10240
s_waitcnt lgkmcnt(7)
v_mfma_f32_32x32x16_bf16 v[96:111], v[128:131], a[24:27], v[96:111]
s_waitcnt vmcnt(16)
ds_read_b128 v[160:163], v56 offset:11264
s_waitcnt lgkmcnt(7)
v_mfma_f32_32x32x16_bf16 v[64:79], v[132:135], a[28:31], v[64:79]
buffer_load_dwordx4 a[68:71], v6, s[32:35], s61 offen offset:1024 sc1
ds_read_b128 v[164:167], v56 offset:12288
s_waitcnt lgkmcnt(7)
v_mfma_f32_32x32x16_bf16 v[80:95], v[136:139], a[28:31], v[80:95]
s_mov_b32 m0, 0x30000
s_mov_b32 s5, 96256
s_sub_u32 s6, s40, 0
s_cmp_lt_u32 s6, 2
s_cselect_b32 s5, 96256, s5
s_add_u32 s6, s4, 59392
s_sub_u32 s7, s40, 0
s_cmp_lt_u32 s7, 2
s_cselect_b32 m0, s6, m0
s_add_u32 s5, s5, s66
buffer_load_dwordx4 v6, s[32:35], s5 offen sc1 lds
ds_read_b128 v[128:131], v56 offset:13312
s_waitcnt lgkmcnt(7)
v_mfma_f32_32x32x16_bf16 v[96:111], v[140:143], a[28:31], v[96:111]
s_waitcnt vmcnt(17)
ds_read_b128 v[132:135], v56 offset:14336
s_waitcnt lgkmcnt(7)
v_mfma_f32_32x32x16_bf16 v[64:79], v[144:147], a[32:35], v[64:79]
buffer_load_dwordx4 a[72:75], v6, s[32:35], s61 offen offset:2048 sc1
ds_read_b128 v[136:139], v56 offset:15360
s_waitcnt lgkmcnt(7)
v_mfma_f32_32x32x16_bf16 v[80:95], v[148:151], a[32:35], v[80:95]
s_add_u32 m0, s4, 61440
s_add_u32 s5, s66, 98304
buffer_load_dwordx4 v6, s[32:35], s5 offen sc1 lds
ds_read_b128 v[140:143], v56 offset:16384
s_waitcnt lgkmcnt(7)
v_mfma_f32_32x32x16_bf16 v[96:111], v[152:155], a[32:35], v[96:111]
s_waitcnt vmcnt(18)
ds_read_b128 v[144:147], v56 offset:17408
s_waitcnt lgkmcnt(7)
v_mfma_f32_32x32x16_bf16 v[64:79], v[156:159], a[36:39], v[64:79]
buffer_load_dwordx4 a[76:79], v6, s[32:35], s61 offen offset:3072 sc1
ds_read_b128 v[148:151], v56 offset:18432
s_waitcnt lgkmcnt(7)
v_mfma_f32_32x32x16_bf16 v[80:95], v[160:163], a[36:39], v[80:95]
s_add_u32 m0, s4, 65536
s_add_u32 s5, s66, 102400
buffer_load_dwordx4 v6, s[32:35], s5 offen sc1 lds
ds_read_b128 v[152:155], v56 offset:19456
s_waitcnt lgkmcnt(7)
v_mfma_f32_32x32x16_bf16 v[96:111], v[164:167], a[36:39], v[96:111]
s_waitcnt vmcnt(19)
ds_read_b128 v[156:159], v56 offset:20480
s_waitcnt lgkmcnt(7)
v_mfma_f32_32x32x16_bf16 v[64:79], v[128:131], a[40:43], v[64:79]
s_add_u32 s61, s61, 4096
buffer_load_dwordx4 a[80:83], v6, s[32:35], s61 offen sc1
ds_read_b128 v[160:163], v56 offset:21504
s_waitcnt lgkmcnt(7)
v_mfma_f32_32x32x16_bf16 v[80:95], v[132:135], a[40:43], v[80:95]
s_add_u32 m0, s4, 69632
s_add_u32 s5, s66, 106496
buffer_load_dwordx4 v6, s[32:35], s5 offen sc1 lds
ds_read_b128 v[164:167], v56 offset:22528
s_waitcnt lgkmcnt(7)
v_mfma_f32_32x32x16_bf16 v[96:111], v[136:139], a[40:43], v[96:111]
s_waitcnt vmcnt(19)
ds_read_b128 v[128:131], v56 offset:23552
s_waitcnt lgkmcnt(7)
v_mfma_f32_32x32x16_bf16 v[64:79], v[140:143], a[44:47], v[64:79]
buffer_load_dwordx4 a[84:87], v6, s[32:35], s61 offen offset:1024 sc1
ds_read_b128 v[132:135], v56 offset:24576
s_waitcnt lgkmcnt(7)
v_mfma_f32_32x32x16_bf16 v[80:95], v[144:147], a[44:47], v[80:95]
s_add_u32 m0, s4, 73728
s_add_u32 s5, s66, 110592
buffer_load_dwordx4 v6, s[32:35], s5 offen sc1 lds
ds_read_b128 v[136:139], v56 offset:25600
s_waitcnt lgkmcnt(7)
v_mfma_f32_32x32x16_bf16 v[96:111], v[148:151], a[44:47], v[96:111]
s_waitcnt vmcnt(19)
ds_read_b128 v[140:143], v56 offset:26624
s_waitcnt lgkmcnt(7)
v_mfma_f32_32x32x16_bf16 v[64:79], v[152:155], a[48:51], v[64:79]
buffer_load_dwordx4 a[88:91], v6, s[32:35], s61 offen offset:2048 sc1
ds_read_b128 v[144:147], v56 offset:27648
s_waitcnt lgkmcnt(7)
v_mfma_f32_32x32x16_bf16 v[80:95], v[156:159], a[48:51], v[80:95]
s_add_u32 m0, s4, 77824
s_add_u32 s5, s66, 114688
buffer_load_dwordx4 v6, s[32:35], s5 offen sc1 lds
ds_read_b128 v[148:151], v56 offset:28672
s_waitcnt lgkmcnt(7)
v_mfma_f32_32x32x16_bf16 v[96:111], v[160:163], a[48:51], v[96:111]
s_waitcnt vmcnt(19)
ds_read_b128 v[152:155], v56 offset:29696
s_waitcnt lgkmcnt(7)
v_mfma_f32_32x32x16_bf16 v[64:79], v[164:167], a[52:55], v[64:79]
buffer_load_dwordx4 a[92:95], v6, s[32:35], s61 offen offset:3072 sc1
ds_read_b128 v[156:159], v56 offset:30720
s_waitcnt lgkmcnt(7)
v_mfma_f32_32x32x16_bf16 v[80:95], v[128:131], a[52:55], v[80:95]
s_add_u32 m0, s4, 81920
s_add_u32 s5, s66, 118784
buffer_load_dwordx4 v6, s[32:35], s5 offen sc1 lds
ds_read_b128 v[160:163], v56 offset:31744
s_waitcnt lgkmcnt(7)
v_mfma_f32_32x32x16_bf16 v[96:111], v[132:135], a[52:55], v[96:111]
s_waitcnt vmcnt(19)
ds_read_b128 v[164:167], v56 offset:32768
s_waitcnt lgkmcnt(7)
v_mfma_f32_32x32x16_bf16 v[64:79], v[136:139], a[56:59], v[64:79]
s_add_u32 s61, s61, 4096
buffer_load_dwordx4 a[96:99], v6, s[32:35], s61 offen sc1
ds_read_b128 v[128:131], v56 offset:33792
s_waitcnt lgkmcnt(7)
v_mfma_f32_32x32x16_bf16 v[80:95], v[140:143], a[56:59], v[80:95]
s_add_u32 m0, s4, 143360
s_add_u32 s5, s67, 133120
buffer_load_dwordx4 v6, s[32:35], s5 offen sc1 lds
ds_read_b128 v[132:135], v56 offset:34816
s_waitcnt lgkmcnt(7)
v_mfma_f32_32x32x16_bf16 v[96:111], v[144:147], a[56:59], v[96:111]
s_waitcnt vmcnt(19)
ds_read_b128 v[136:139], v56 offset:35840
s_waitcnt lgkmcnt(7)
v_mfma_f32_32x32x16_bf16 v[64:79], v[148:151], a[60:63], v[64:79]
buffer_load_dwordx4 a[100:103], v6, s[32:35], s61 offen offset:1024 sc1
ds_read_b128 v[140:143], v56 offset:36864
s_waitcnt lgkmcnt(7)
v_mfma_f32_32x32x16_bf16 v[80:95], v[152:155], a[60:63], v[80:95]
s_add_u32 m0, s4, 147456
s_add_u32 s5, s67, 137216
buffer_load_dwordx4 v6, s[32:35], s5 offen sc1 lds
ds_read_b128 v[144:147], v56 offset:37888
s_waitcnt lgkmcnt(7)
v_mfma_f32_32x32x16_bf16 v[96:111], v[156:159], a[60:63], v[96:111]
s_waitcnt vmcnt(19)
ds_read_b128 v[148:151], v56 offset:38912
s_waitcnt lgkmcnt(7)
v_mfma_f32_32x32x16_bf16 v[64:79], v[160:163], a[64:67], v[64:79]
buffer_load_dwordx4 a[104:107], v6, s[32:35], s61 offen offset:2048 sc1
ds_read_b128 v[152:155], v56 offset:39936
s_waitcnt lgkmcnt(7)
v_mfma_f32_32x32x16_bf16 v[80:95], v[164:167], a[64:67], v[80:95]
s_add_u32 m0, s4, 151552
s_add_u32 s5, s67, 141312
buffer_load_dwordx4 v6, s[32:35], s5 offen sc1 lds
ds_read_b128 v[156:159], v56 offset:40960
s_waitcnt lgkmcnt(7)
v_mfma_f32_32x32x16_bf16 v[96:111], v[128:131], a[64:67], v[96:111]
s_waitcnt vmcnt(19)
ds_read_b128 v[160:163], v56 offset:41984
s_waitcnt lgkmcnt(7)
v_mfma_f32_32x32x16_bf16 v[64:79], v[132:135], a[68:71], v[64:79]
buffer_load_dwordx4 a[108:111], v6, s[32:35], s61 offen offset:3072 sc1
ds_read_b128 v[164:167], v56 offset:43008
s_waitcnt lgkmcnt(7)
v_mfma_f32_32x32x16_bf16 v[80:95], v[136:139], a[68:71], v[80:95]
s_add_u32 m0, s4, 155648
s_add_u32 s5, s67, 145408
buffer_load_dwordx4 v6, s[32:35], s5 offen sc1 lds
ds_read_b128 v[128:131], v56 offset:44032
s_waitcnt lgkmcnt(7)
v_mfma_f32_32x32x16_bf16 v[96:111], v[140:143], a[68:71], v[96:111]
s_waitcnt vmcnt(19)
ds_read_b128 v[132:135], v56 offset:45056
s_waitcnt lgkmcnt(7)
v_mfma_f32_32x32x16_bf16 v[64:79], v[144:147], a[72:75], v[64:79]
s_add_u32 s61, s61, 4096
buffer_load_dwordx4 a[112:115], v6, s[32:35], s61 offen sc1
ds_read_b128 v[136:139], v56 offset:46080
s_waitcnt lgkmcnt(7)
v_mfma_f32_32x32x16_bf16 v[80:95], v[148:151], a[72:75], v[80:95]
s_add_u32 m0, s4, 159744
s_add_u32 s5, s67, 149504
buffer_load_dwordx4 v6, s[32:35], s5 offen sc1 lds
ds_read_b128 v[140:143], v56 offset:47104
s_waitcnt lgkmcnt(7)
v_mfma_f32_32x32x16_bf16 v[96:111], v[152:155], a[72:75], v[96:111]
s_waitcnt vmcnt(19)
ds_read_b128 v[144:147], v56 offset:48128
s_waitcnt lgkmcnt(7)
v_mfma_f32_32x32x16_bf16 v[64:79], v[156:159], a[76:79], v[64:79]
buffer_load_dwordx4 a[116:119], v6, s[32:35], s61 offen offset:1024 sc1
ds_read_b128 v[148:151], v56 offset:49152
s_waitcnt lgkmcnt(7)
v_mfma_f32_32x32x16_bf16 v[80:95], v[160:163], a[76:79], v[80:95]
s_barrier
v_add_u32 v56, -61440, v56
ds_read_b128 v[152:155], v56 offset:0
s_waitcnt lgkmcnt(7)
v_mfma_f32_32x32x16_bf16 v[96:111], v[164:167], a[76:79], v[96:111]
s_waitcnt vmcnt(18)
ds_read_b128 v[156:159], v56 offset:1024
s_waitcnt lgkmcnt(7)
v_mfma_f32_32x32x16_bf16 v[64:79], v[128:131], a[80:83], v[64:79]
buffer_load_dwordx4 a[120:123], v6, s[32:35], s61 offen offset:2048 sc1
ds_read_b128 v[160:163], v56 offset:2048
s_waitcnt lgkmcnt(7)
v_mfma_f32_32x32x16_bf16 v[80:95], v[132:135], a[80:83], v[80:95]
v_accvgpr_read_b32 v252, a235
s_mov_b32 s56, s60
buffer_load_dwordx2 v[244:245], v252, s[32:35], s56 offen sc1
s_add_u32 s56, s56, 16384
buffer_load_dwordx2 v[246:247], v252, s[32:35], s56 offen sc1
s_add_u32 s56, s56, 16384
buffer_load_dwordx2 v[248:249], v252, s[32:35], s56 offen sc1
s_add_u32 s56, s56, 16384
buffer_load_dwordx2 v[250:251], v252, s[32:35], s56 offen sc1
buffer_load_dword v238, v242, s[32:35], s59 offen offset:0 sc1
buffer_load_dword v239, v242, s[32:35], s59 offen offset:512 sc1
buffer_load_dword v240, v242, s[32:35], s59 offen offset:1024 sc1
buffer_load_dword v241, v242, s[32:35], s59 offen offset:1536 sc1
ds_read_b128 v[164:167], v56 offset:3072
s_waitcnt lgkmcnt(7)
v_mfma_f32_32x32x16_bf16 v[96:111], v[136:139], a[80:83], v[96:111]
s_waitcnt vmcnt(25)
ds_read_b128 v[128:131], v56 offset:4096
s_waitcnt lgkmcnt(7)
v_mfma_f32_32x32x16_bf16 v[64:79], v[140:143], a[84:87], v[64:79]
buffer_load_dwordx4 a[124:127], v6, s[32:35], s61 offen offset:3072 sc1
ds_read_b128 v[132:135], v56 offset:5120
s_waitcnt lgkmcnt(7)
v_mfma_f32_32x32x16_bf16 v[80:95], v[144:147], a[84:87], v[80:95]
ds_read_b128 v[136:139], v56 offset:6144
s_waitcnt lgkmcnt(7)
v_mfma_f32_32x32x16_bf16 v[96:111], v[148:151], a[84:87], v[96:111]
s_waitcnt vmcnt(24)
ds_read_b128 v[140:143], v56 offset:7168
s_waitcnt lgkmcnt(7)
v_mfma_f32_32x32x16_bf16 v[64:79], v[152:155], a[88:91], v[64:79]
s_add_u32 s61, s61, 4096
buffer_load_dwordx4 a[128:131], v6, s[32:35], s61 offen sc1
ds_read_b128 v[144:147], v56 offset:8192
s_waitcnt lgkmcnt(7)
v_mfma_f32_32x32x16_bf16 v[80:95], v[156:159], a[88:91], v[80:95]
ds_read_b128 v[148:151], v56 offset:9216
s_waitcnt lgkmcnt(7)
v_mfma_f32_32x32x16_bf16 v[96:111], v[160:163], a[88:91], v[96:111]
s_barrier
s_waitcnt vmcnt(23)
ds_read_b128 v[152:155], v56 offset:10240
s_waitcnt lgkmcnt(7)
v_mfma_f32_32x32x16_bf16 v[64:79], v[164:167], a[92:95], v[64:79]
buffer_load_dwordx4 a[132:135], v6, s[32:35], s61 offen offset:1024 sc1
ds_read_b128 v[156:159], v56 offset:11264
s_waitcnt lgkmcnt(7)
v_mfma_f32_32x32x16_bf16 v[80:95], v[128:131], a[92:95], v[80:95]
s_add_u32 m0, s4, 102400
s_add_u32 s5, s67, 92160
buffer_load_dwordx4 v6, s[32:35], s5 offen sc1 lds
ds_read_b128 v[160:163], v56 offset:12288
s_waitcnt lgkmcnt(7)
v_mfma_f32_32x32x16_bf16 v[96:111], v[132:135], a[92:95], v[96:111]
s_waitcnt vmcnt(23)
ds_read_b128 v[164:167], v56 offset:13312
s_waitcnt lgkmcnt(7)
v_mfma_f32_32x32x16_bf16 v[64:79], v[136:139], a[96:99], v[64:79]
buffer_load_dwordx4 a[136:139], v6, s[32:35], s61 offen offset:2048 sc1
ds_read_b128 v[128:131], v56 offset:14336
s_waitcnt lgkmcnt(7)
v_mfma_f32_32x32x16_bf16 v[80:95], v[140:143], a[96:99], v[80:95]
s_add_u32 m0, s4, 106496
s_add_u32 s5, s67, 96256
buffer_load_dwordx4 v6, s[32:35], s5 offen sc1 lds
ds_read_b128 v[132:135], v56 offset:15360
s_waitcnt lgkmcnt(7)
v_mfma_f32_32x32x16_bf16 v[96:111], v[144:147], a[96:99], v[96:111]
s_waitcnt vmcnt(23)
ds_read_b128 v[136:139], v56 offset:16384
s_waitcnt lgkmcnt(7)
v_mfma_f32_32x32x16_bf16 v[64:79], v[148:151], a[100:103], v[64:79]
buffer_load_dwordx4 a[140:143], v6, s[32:35], s61 offen offset:3072 sc1
ds_read_b128 v[140:143], v56 offset:17408
s_waitcnt lgkmcnt(7)
v_mfma_f32_32x32x16_bf16 v[80:95], v[152:155], a[100:103], v[80:95]
s_add_u32 m0, s4, 110592
s_add_u32 s5, s67, 100352
buffer_load_dwordx4 v6, s[32:35], s5 offen sc1 lds
ds_read_b128 v[144:147], v56 offset:18432
s_waitcnt lgkmcnt(7)
v_mfma_f32_32x32x16_bf16 v[96:111], v[156:159], a[100:103], v[96:111]
s_waitcnt vmcnt(23)
ds_read_b128 v[148:151], v56 offset:19456
s_waitcnt lgkmcnt(7)
v_mfma_f32_32x32x16_bf16 v[64:79], v[160:163], a[104:107], v[64:79]
s_add_u32 s61, s61, 4096
buffer_load_dwordx4 a[144:147], v6, s[32:35], s61 offen sc1
ds_read_b128 v[152:155], v56 offset:20480
s_waitcnt lgkmcnt(7)
v_mfma_f32_32x32x16_bf16 v[80:95], v[164:167], a[104:107], v[80:95]
s_add_u32 m0, s4, 114688
s_add_u32 s5, s67, 104448
buffer_load_dwordx4 v6, s[32:35], s5 offen sc1 lds
ds_read_b128 v[156:159], v56 offset:21504
s_waitcnt lgkmcnt(7)
v_mfma_f32_32x32x16_bf16 v[96:111], v[128:131], a[104:107], v[96:111]
s_waitcnt vmcnt(23)
ds_read_b128 v[160:163], v56 offset:22528
s_waitcnt lgkmcnt(7)
v_mfma_f32_32x32x16_bf16 v[64:79], v[132:135], a[108:111], v[64:79]
buffer_load_dwordx4 a[148:151], v6, s[32:35], s61 offen offset:1024 sc1
ds_read_b128 v[164:167], v56 offset:23552
s_waitcnt lgkmcnt(7)
v_mfma_f32_32x32x16_bf16 v[80:95], v[136:139], a[108:111], v[80:95]
s_add_u32 m0, s4, 118784
s_add_u32 s5, s67, 108544
buffer_load_dwordx4 v6, s[32:35], s5 offen sc1 lds
ds_read_b128 v[128:131], v56 offset:24576
s_waitcnt lgkmcnt(7)
v_mfma_f32_32x32x16_bf16 v[96:111], v[140:143], a[108:111], v[96:111]
s_waitcnt vmcnt(23)
ds_read_b128 v[132:135], v56 offset:25600
s_waitcnt lgkmcnt(7)
v_mfma_f32_32x32x16_bf16 v[64:79], v[144:147], a[112:115], v[64:79]
buffer_load_dwordx4 a[152:155], v6, s[32:35], s61 offen offset:2048 sc1
ds_read_b128 v[136:139], v56 offset:26624
s_waitcnt lgkmcnt(7)
v_mfma_f32_32x32x16_bf16 v[80:95], v[148:151], a[112:115], v[80:95]
s_add_u32 m0, s4, 122880
s_add_u32 s5, s67, 112640
buffer_load_dwordx4 v6, s[32:35], s5 offen sc1 lds
ds_read_b128 v[140:143], v56 offset:27648
s_waitcnt lgkmcnt(7)
v_mfma_f32_32x32x16_bf16 v[96:111], v[152:155], a[112:115], v[96:111]
s_waitcnt vmcnt(23)
ds_read_b128 v[144:147], v56 offset:28672
s_waitcnt lgkmcnt(7)
v_mfma_f32_32x32x16_bf16 v[64:79], v[156:159], a[116:119], v[64:79]
buffer_load_dwordx4 a[156:159], v6, s[32:35], s61 offen offset:3072 sc1
ds_read_b128 v[148:151], v56 offset:29696
s_waitcnt lgkmcnt(7)
v_mfma_f32_32x32x16_bf16 v[80:95], v[160:163], a[116:119], v[80:95]
s_add_u32 m0, s4, 126976
s_add_u32 s5, s67, 116736
buffer_load_dwordx4 v6, s[32:35], s5 offen sc1 lds
s_barrier
ds_read_b128 v[152:155], v56 offset:30720
s_waitcnt lgkmcnt(7)
v_mfma_f32_32x32x16_bf16 v[96:111], v[164:167], a[116:119], v[96:111]
s_waitcnt vmcnt(24)
ds_read_b128 v[156:159], v56 offset:31744
s_waitcnt lgkmcnt(7)
v_mfma_f32_32x32x16_bf16 v[64:79], v[128:131], a[120:123], v[64:79]
ds_read_b128 v[160:163], v56 offset:32768
s_waitcnt lgkmcnt(7)
v_mfma_f32_32x32x16_bf16 v[80:95], v[132:135], a[120:123], v[80:95]
s_add_u32 m0, s4, 131072
s_add_u32 s5, s67, 120832
buffer_load_dwordx4 v6, s[32:35], s5 offen sc1 lds
ds_read_b128 v[164:167], v56 offset:33792
s_waitcnt lgkmcnt(7)
v_mfma_f32_32x32x16_bf16 v[96:111], v[136:139], a[120:123], v[96:111]
s_waitcnt vmcnt(16)
ds_read_b128 v[128:131], v56 offset:34816
s_waitcnt lgkmcnt(7)
v_mfma_f32_32x32x16_bf16 v[64:79], v[140:143], a[124:127], v[64:79]
ds_read_b128 v[132:135], v56 offset:35840
s_waitcnt lgkmcnt(7)
v_mfma_f32_32x32x16_bf16 v[80:95], v[144:147], a[124:127], v[80:95]
s_add_u32 m0, s4, 135168
s_add_u32 s5, s67, 124928
buffer_load_dwordx4 v6, s[32:35], s5 offen sc1 lds
ds_read_b128 v[136:139], v56 offset:36864
s_waitcnt lgkmcnt(7)
v_mfma_f32_32x32x16_bf16 v[96:111], v[148:151], a[124:127], v[96:111]
s_waitcnt vmcnt(16)
ds_read_b128 v[140:143], v56 offset:37888
s_waitcnt lgkmcnt(7)
v_mfma_f32_32x32x16_bf16 v[64:79], v[152:155], a[128:131], v[64:79]
ds_read_b128 v[144:147], v56 offset:38912
s_waitcnt lgkmcnt(7)
v_mfma_f32_32x32x16_bf16 v[80:95], v[156:159], a[128:131], v[80:95]
s_add_u32 m0, s4, 139264
s_add_u32 s5, s67, 129024
buffer_load_dwordx4 v6, s[32:35], s5 offen sc1 lds
ds_read_b128 v[148:151], v56 offset:39936
s_waitcnt lgkmcnt(7)
v_mfma_f32_32x32x16_bf16 v[96:111], v[160:163], a[128:131], v[96:111]
s_waitcnt vmcnt(16)
ds_read_b128 v[152:155], v56 offset:40960
s_waitcnt lgkmcnt(7)
v_mfma_f32_32x32x16_bf16 v[64:79], v[164:167], a[132:135], v[64:79]
ds_read_b128 v[156:159], v56 offset:41984
s_waitcnt lgkmcnt(7)
v_mfma_f32_32x32x16_bf16 v[80:95], v[128:131], a[132:135], v[80:95]
ds_read_b128 v[160:163], v56 offset:43008
s_waitcnt lgkmcnt(7)
v_mfma_f32_32x32x16_bf16 v[96:111], v[132:135], a[132:135], v[96:111]
s_waitcnt vmcnt(14)
ds_read_b128 v[164:167], v56 offset:44032
s_waitcnt lgkmcnt(7)
v_mfma_f32_32x32x16_bf16 v[64:79], v[136:139], a[136:139], v[64:79]
ds_read_b128 v[128:131], v56 offset:45056
s_waitcnt lgkmcnt(7)
v_mfma_f32_32x32x16_bf16 v[80:95], v[140:143], a[136:139], v[80:95]
ds_read_b128 v[132:135], v56 offset:46080
s_waitcnt lgkmcnt(7)
v_mfma_f32_32x32x16_bf16 v[96:111], v[144:147], a[136:139], v[96:111]
v_add_f32 v238, v238, v239
v_add_f32 v240, v240, v241
v_accvgpr_read_b32 v242, a237
v_add_f32 v238, v238, v240
s_waitcnt vmcnt(12)
ds_read_b128 v[136:139], v56 offset:47104
s_waitcnt lgkmcnt(7)
v_mfma_f32_32x32x16_bf16 v[64:79], v[148:151], a[140:143], v[64:79]
ds_read_b128 v[140:143], v56 offset:48128
s_waitcnt lgkmcnt(7)
v_mfma_f32_32x32x16_bf16 v[80:95], v[152:155], a[140:143], v[80:95]
ds_read_b128 v[144:147], v56 offset:49152
s_waitcnt lgkmcnt(7)
v_mfma_f32_32x32x16_bf16 v[96:111], v[156:159], a[140:143], v[96:111]
ds_write_b32 v242, v238 offset:512
v_pk_add_f32 v[244:245], v[244:245], v[246:247]
v_pk_add_f32 v[248:249], v[248:249], v[250:251]
v_pk_add_f32 v[244:245], v[244:245], v[248:249]
v_mov_b32 v252, v244
s_waitcnt vmcnt(10)
ds_read_b128 v[148:151], v56 offset:50176
s_waitcnt lgkmcnt(8)
v_mfma_f32_32x32x16_bf16 v[64:79], v[160:163], a[144:147], v[64:79]
ds_read_b128 v[152:155], v56 offset:51200
s_waitcnt lgkmcnt(8)
v_mfma_f32_32x32x16_bf16 v[80:95], v[164:167], a[144:147], v[80:95]
ds_read_b128 v[156:159], v56 offset:52224
s_waitcnt lgkmcnt(8)
v_mfma_f32_32x32x16_bf16 v[96:111], v[128:131], a[144:147], v[96:111]
v_mov_b32 v253, v245
v_permlane32_swap_b32 v244, v252
s_nop 0
v_permlane32_swap_b32 v245, v253
v_add_f32 v244, v244, v252
v_add_f32 v245, v245, v253
s_waitcnt vmcnt(8)
ds_read_b128 v[160:163], v56 offset:53248
s_waitcnt lgkmcnt(8)
v_mfma_f32_32x32x16_bf16 v[64:79], v[132:135], a[148:151], v[64:79]
ds_read_b128 v[164:167], v56 offset:54272
s_waitcnt lgkmcnt(8)
v_mfma_f32_32x32x16_bf16 v[80:95], v[136:139], a[148:151], v[80:95]
s_waitcnt lgkmcnt(7)
v_mfma_f32_32x32x16_bf16 v[96:111], v[140:143], a[148:151], v[96:111]
s_mov_b32 s91, 986500301
v_mul_f32 v244, s91, v244
v_mul_f32 v245, s91, v245
v_fma_f32 v245, -v244, v244, v245
v_max_f32 v245, 0, v245
s_waitcnt vmcnt(6)
s_waitcnt lgkmcnt(6)
v_mfma_f32_32x32x16_bf16 v[64:79], v[144:147], a[152:155], v[64:79]
s_waitcnt lgkmcnt(4)
v_mfma_f32_32x32x16_bf16 v[80:95], v[148:151], a[152:155], v[80:95]
s_waitcnt lgkmcnt(3)
v_mfma_f32_32x32x16_bf16 v[96:111], v[152:155], a[152:155], v[96:111]
v_sub_f32 v12, 0, v244
s_mov_b32 s91, 925353388
v_add_f32 v252, s91, v245
v_rsq_f32 v13, v252
s_nop 0
v_mul_f32 v253, v13, v13
s_waitcnt vmcnt(4)
s_waitcnt lgkmcnt(2)
v_mfma_f32_32x32x16_bf16 v[64:79], v[156:159], a[156:159], v[64:79]
s_waitcnt lgkmcnt(1)
v_mfma_f32_32x32x16_bf16 v[80:95], v[160:163], a[156:159], v[80:95]
s_waitcnt lgkmcnt(0)
v_mfma_f32_32x32x16_bf16 v[96:111], v[164:167], a[156:159], v[96:111]
v_fma_f32 v253, v253, v245, s91
v_rsq_f32 v253, v253
s_nop 0
v_mul_f32 v13, v13, v253
v_lshlrev_b32 v15, 4, v3
v_accvgpr_read_b32 v168, a234
v_mov_b32 v170, 3222493025
v_mov_b32 v171, 3184710632
s_lshl_b32 s56, s8, 23
s_add_u32 s56, s56, 41943040
s_mul_i32 s57, s41, 393216
s_add_u32 s56, s56, s57
s_mul_i32 s57, s40, 98304
s_add_u32 s56, s56, s57
s_mul_i32 s57, s42, 3072
s_add_u32 s56, s56, s57
s_waitcnt lgkmcnt(0)
s_barrier
ds_read_b128 v[172:175], v15 offset:512
ds_read_b128 v[188:191], v15 offset:1024
ds_read_b128 v[176:179], v15 offset:544
ds_read_b128 v[192:195], v15 offset:1056
ds_read_b128 v[180:183], v15 offset:576
ds_read_b128 v[196:199], v15 offset:1088
ds_read_b128 v[184:187], v15 offset:608
ds_read_b128 v[200:203], v15 offset:1120
s_waitcnt lgkmcnt(0)
v_pk_fma_f32 v[172:173], v[12:13], v[172:173], v[64:65] op_sel_hi:[0,1,1]
v_pk_fma_f32 v[172:173], v[172:173], v[12:13], v[188:189] op_sel:[0,1,0] op_sel_hi:[1,1,1]
s_add_u32 m0, s4, 81920
s_add_u32 s5, s67, 0
buffer_load_dwordx4 v6, s[32:35], s5 offen sc1 lds
v_pk_fma_f32 v[174:175], v[12:13], v[174:175], v[66:67] op_sel_hi:[0,1,1]
v_pk_fma_f32 v[174:175], v[174:175], v[12:13], v[190:191] op_sel:[0,1,0] op_sel_hi:[1,1,1]
v_pk_fma_f32 v[176:177], v[12:13], v[176:177], v[68:69] op_sel_hi:[0,1,1]
v_pk_fma_f32 v[176:177], v[176:177], v[12:13], v[192:193] op_sel:[0,1,0] op_sel_hi:[1,1,1]
v_pk_fma_f32 v[178:179], v[12:13], v[178:179], v[70:71] op_sel_hi:[0,1,1]
v_pk_fma_f32 v[178:179], v[178:179], v[12:13], v[194:195] op_sel:[0,1,0] op_sel_hi:[1,1,1]
v_pk_fma_f32 v[180:181], v[12:13], v[180:181], v[72:73] op_sel_hi:[0,1,1]
s_add_u32 m0, s4, 86016
s_add_u32 s5, s67, 4096
buffer_load_dwordx4 v6, s[32:35], s5 offen sc1 lds
v_pk_fma_f32 v[180:181], v[180:181], v[12:13], v[196:197] op_sel:[0,1,0] op_sel_hi:[1,1,1]
v_pk_fma_f32 v[182:183], v[12:13], v[182:183], v[74:75] op_sel_hi:[0,1,1]
v_pk_fma_f32 v[182:183], v[182:183], v[12:13], v[198:199] op_sel:[0,1,0] op_sel_hi:[1,1,1]
v_pk_fma_f32 v[184:185], v[12:13], v[184:185], v[76:77] op_sel_hi:[0,1,1]
v_pk_fma_f32 v[184:185], v[184:185], v[12:13], v[200:201] op_sel:[0,1,0] op_sel_hi:[1,1,1]
v_pk_fma_f32 v[186:187], v[12:13], v[186:187], v[78:79] op_sel_hi:[0,1,1]
v_pk_fma_f32 v[186:187], v[186:187], v[12:13], v[202:203] op_sel:[0,1,0] op_sel_hi:[1,1,1]
s_mov_b32 m0, 0x30000
s_mov_b32 s5, 8192
s_sub_u32 s6, s40, 0
s_cmp_lt_u32 s6, 2
s_cselect_b32 s5, 8192, s5
s_add_u32 s6, s4, 90112
s_sub_u32 s7, s40, 0
s_cmp_lt_u32 s7, 2
s_cselect_b32 m0, s6, m0
s_sub_u32 s6, s40, 2
s_cmp_lt_u32 s6, 2
s_cselect_b32 s5, 8192, s5
s_add_u32 s6, s4, 8192
s_sub_u32 s7, s40, 2
s_cmp_lt_u32 s7, 2
s_cselect_b32 m0, s6, m0
s_add_u32 s5, s5, s67
buffer_load_dwordx4 v6, s[32:35], s5 offen sc1 lds
v_pk_mul_f32 v[204:205], v[172:173], v[172:173]
v_pk_fma_f32 v[204:205], v[204:205], v[170:171], v[170:171] op_sel:[0,1,0] op_sel_hi:[1,1,0]
v_pk_mul_f32 v[204:205], v[204:205], v[172:173]
v_pk_mul_f32 v[206:207], v[174:175], v[174:175]
v_pk_fma_f32 v[206:207], v[206:207], v[170:171], v[170:171] op_sel:[0,1,0] op_sel_hi:[1,1,0]
v_pk_mul_f32 v[206:207], v[206:207], v[174:175]
v_pk_mul_f32 v[208:209], v[176:177], v[176:177]
s_add_u32 m0, s4, 12288
s_add_u32 s5, s67, 12288
buffer_load_dwordx4 v6, s[32:35], s5 offen sc1 lds
v_pk_fma_f32 v[208:209], v[208:209], v[170:171], v[170:171] op_sel:[0,1,0] op_sel_hi:[1,1,0]
v_pk_mul_f32 v[208:209], v[208:209], v[176:177]
v_pk_mul_f32 v[210:211], v[178:179], v[178:179]
v_pk_fma_f32 v[210:211], v[210:211], v[170:171], v[170:171] op_sel:[0,1,0] op_sel_hi:[1,1,0]
v_pk_mul_f32 v[210:211], v[210:211], v[178:179]
v_pk_mul_f32 v[212:213], v[180:181], v[180:181]
v_pk_fma_f32 v[212:213], v[212:213], v[170:171], v[170:171] op_sel:[0,1,0] op_sel_hi:[1,1,0]
s_add_u32 m0, s4, 16384
s_add_u32 s5, s67, 16384
buffer_load_dwordx4 v6, s[32:35], s5 offen sc1 lds
v_pk_mul_f32 v[212:213], v[212:213], v[180:181]
v_pk_mul_f32 v[214:215], v[182:183], v[182:183]
v_pk_fma_f32 v[214:215], v[214:215], v[170:171], v[170:171] op_sel:[0,1,0] op_sel_hi:[1,1,0]
v_pk_mul_f32 v[214:215], v[214:215], v[182:183]
v_pk_mul_f32 v[216:217], v[184:185], v[184:185]
v_pk_fma_f32 v[216:217], v[216:217], v[170:171], v[170:171] op_sel:[0,1,0] op_sel_hi:[1,1,0]
v_pk_mul_f32 v[216:217], v[216:217], v[184:185]
s_add_u32 m0, s4, 20480
s_add_u32 s5, s67, 20480
buffer_load_dwordx4 v6, s[32:35], s5 offen sc1 lds
v_pk_mul_f32 v[218:219], v[186:187], v[186:187]
v_pk_fma_f32 v[218:219], v[218:219], v[170:171], v[170:171] op_sel:[0,1,0] op_sel_hi:[1,1,0]
v_pk_mul_f32 v[218:219], v[218:219], v[186:187]
v_exp_f32 v204, v204
v_exp_f32 v205, v205
v_exp_f32 v206, v206
v_exp_f32 v207, v207
s_add_u32 m0, s4, 24576
s_add_u32 s5, s67, 24576
buffer_load_dwordx4 v6, s[32:35], s5 offen sc1 lds
v_exp_f32 v208, v208
v_exp_f32 v209, v209
v_exp_f32 v210, v210
v_exp_f32 v211, v211
v_exp_f32 v212, v212
v_exp_f32 v213, v213
v_exp_f32 v214, v214
s_add_u32 m0, s4, 28672
s_add_u32 s5, s67, 28672
buffer_load_dwordx4 v6, s[32:35], s5 offen sc1 lds
v_exp_f32 v215, v215
v_exp_f32 v216, v216
v_exp_f32 v217, v217
v_exp_f32 v218, v218
v_exp_f32 v219, v219
v_pk_add_f32 v[204:205], v[204:205], 1.0 op_sel_hi:[1,0]
v_pk_add_f32 v[206:207], v[206:207], 1.0 op_sel_hi:[1,0]
s_add_u32 m0, s4, 32768
s_add_u32 s5, s67, 32768
buffer_load_dwordx4 v6, s[32:35], s5 offen sc1 lds
v_pk_add_f32 v[208:209], v[208:209], 1.0 op_sel_hi:[1,0]
v_pk_add_f32 v[210:211], v[210:211], 1.0 op_sel_hi:[1,0]
v_pk_add_f32 v[212:213], v[212:213], 1.0 op_sel_hi:[1,0]
v_pk_add_f32 v[214:215], v[214:215], 1.0 op_sel_hi:[1,0]
v_pk_add_f32 v[216:217], v[216:217], 1.0 op_sel_hi:[1,0]
v_pk_add_f32 v[218:219], v[218:219], 1.0 op_sel_hi:[1,0]
v_rcp_f32 v204, v204
s_add_u32 m0, s4, 36864
s_add_u32 s5, s67, 36864
buffer_load_dwordx4 v6, s[32:35], s5 offen sc1 lds
v_rcp_f32 v205, v205
v_rcp_f32 v206, v206
v_rcp_f32 v207, v207
v_rcp_f32 v208, v208
v_rcp_f32 v209, v209
v_rcp_f32 v210, v210
v_rcp_f32 v211, v211
s_add_u32 m0, s4, 40960
s_add_u32 s5, s67, 40960
buffer_load_dwordx4 v6, s[32:35], s5 offen sc1 lds
v_rcp_f32 v212, v212
v_rcp_f32 v213, v213
v_rcp_f32 v214, v214
v_rcp_f32 v215, v215
v_rcp_f32 v216, v216
v_rcp_f32 v217, v217
v_rcp_f32 v218, v218
s_add_u32 m0, s4, 45056
s_add_u32 s5, s67, 45056
buffer_load_dwordx4 v6, s[32:35], s5 offen sc1 lds
v_rcp_f32 v219, v219
v_pk_mul_f32 v[204:205], v[204:205], v[172:173]
v_pk_mul_f32 v[206:207], v[206:207], v[174:175]
v_pk_mul_f32 v[208:209], v[208:209], v[176:177]
v_pk_mul_f32 v[210:211], v[210:211], v[178:179]
v_pk_mul_f32 v[212:213], v[212:213], v[180:181]
v_pk_mul_f32 v[214:215], v[214:215], v[182:183]
s_add_u32 m0, s4, 49152
s_add_u32 s5, s67, 49152
buffer_load_dwordx4 v6, s[32:35], s5 offen sc1 lds
v_pk_mul_f32 v[216:217], v[216:217], v[184:185]
v_pk_mul_f32 v[218:219], v[218:219], v[186:187]
v_cvt_pk_bf16_f32 v220, v204, v205
v_cvt_pk_bf16_f32 v221, v206, v207
v_cvt_pk_bf16_f32 v222, v208, v209
v_cvt_pk_bf16_f32 v223, v210, v211
v_cvt_pk_bf16_f32 v224, v212, v213
s_add_u32 m0, s4, 53248
s_add_u32 s5, s67, 53248
buffer_load_dwordx4 v6, s[32:35], s5 offen sc1 lds
v_cvt_pk_bf16_f32 v225, v214, v215
v_cvt_pk_bf16_f32 v226, v216, v217
v_cvt_pk_bf16_f32 v227, v218, v219
buffer_store_dwordx4 v[220:223], v168, s[32:35], s56 offen sc1
buffer_store_dwordx4 v[224:227], v168, s[32:35], s56 offen offset:512 sc1
ds_read_b128 v[172:175], v15 offset:640
ds_read_b128 v[188:191], v15 offset:1152
ds_read_b128 v[176:179], v15 offset:672
ds_read_b128 v[192:195], v15 offset:1184
ds_read_b128 v[180:183], v15 offset:704
ds_read_b128 v[196:199], v15 offset:1216
ds_read_b128 v[184:187], v15 offset:736
ds_read_b128 v[200:203], v15 offset:1248
s_waitcnt lgkmcnt(0)
v_pk_fma_f32 v[172:173], v[12:13], v[172:173], v[80:81] op_sel_hi:[0,1,1]
v_pk_fma_f32 v[172:173], v[172:173], v[12:13], v[188:189] op_sel:[0,1,0] op_sel_hi:[1,1,1]
s_add_u32 m0, s4, 57344
s_add_u32 s5, s67, 57344
buffer_load_dwordx4 v6, s[32:35], s5 offen sc1 lds
v_pk_fma_f32 v[174:175], v[12:13], v[174:175], v[82:83] op_sel_hi:[0,1,1]
v_pk_fma_f32 v[174:175], v[174:175], v[12:13], v[190:191] op_sel:[0,1,0] op_sel_hi:[1,1,1]
v_pk_fma_f32 v[176:177], v[12:13], v[176:177], v[84:85] op_sel_hi:[0,1,1]
v_pk_fma_f32 v[176:177], v[176:177], v[12:13], v[192:193] op_sel:[0,1,0] op_sel_hi:[1,1,1]
v_pk_fma_f32 v[178:179], v[12:13], v[178:179], v[86:87] op_sel_hi:[0,1,1]
v_pk_fma_f32 v[178:179], v[178:179], v[12:13], v[194:195] op_sel:[0,1,0] op_sel_hi:[1,1,1]
v_pk_fma_f32 v[180:181], v[12:13], v[180:181], v[88:89] op_sel_hi:[0,1,1]
s_add_u32 m0, s4, 61440
s_add_u32 s5, s67, 61440
buffer_load_dwordx4 v6, s[32:35], s5 offen sc1 lds
v_pk_fma_f32 v[180:181], v[180:181], v[12:13], v[196:197] op_sel:[0,1,0] op_sel_hi:[1,1,1]
v_pk_fma_f32 v[182:183], v[12:13], v[182:183], v[90:91] op_sel_hi:[0,1,1]
v_pk_fma_f32 v[182:183], v[182:183], v[12:13], v[198:199] op_sel:[0,1,0] op_sel_hi:[1,1,1]
v_pk_fma_f32 v[184:185], v[12:13], v[184:185], v[92:93] op_sel_hi:[0,1,1]
v_pk_fma_f32 v[184:185], v[184:185], v[12:13], v[200:201] op_sel:[0,1,0] op_sel_hi:[1,1,1]
v_pk_fma_f32 v[186:187], v[12:13], v[186:187], v[94:95] op_sel_hi:[0,1,1]
v_pk_fma_f32 v[186:187], v[186:187], v[12:13], v[202:203] op_sel:[0,1,0] op_sel_hi:[1,1,1]
s_add_u32 m0, s4, 65536
s_add_u32 s5, s67, 65536
buffer_load_dwordx4 v6, s[32:35], s5 offen sc1 lds
v_pk_mul_f32 v[204:205], v[172:173], v[172:173]
v_pk_fma_f32 v[204:205], v[204:205], v[170:171], v[170:171] op_sel:[0,1,0] op_sel_hi:[1,1,0]
v_pk_mul_f32 v[204:205], v[204:205], v[172:173]
v_pk_mul_f32 v[206:207], v[174:175], v[174:175]
v_pk_fma_f32 v[206:207], v[206:207], v[170:171], v[170:171] op_sel:[0,1,0] op_sel_hi:[1,1,0]
v_pk_mul_f32 v[206:207], v[206:207], v[174:175]
v_pk_mul_f32 v[208:209], v[176:177], v[176:177]
s_add_u32 m0, s4, 69632
s_add_u32 s5, s67, 69632
buffer_load_dwordx4 v6, s[32:35], s5 offen sc1 lds
v_pk_fma_f32 v[208:209], v[208:209], v[170:171], v[170:171] op_sel:[0,1,0] op_sel_hi:[1,1,0]
v_pk_mul_f32 v[208:209], v[208:209], v[176:177]
v_pk_mul_f32 v[210:211], v[178:179], v[178:179]
v_pk_fma_f32 v[210:211], v[210:211], v[170:171], v[170:171] op_sel:[0,1,0] op_sel_hi:[1,1,0]
v_pk_mul_f32 v[210:211], v[210:211], v[178:179]
v_pk_mul_f32 v[212:213], v[180:181], v[180:181]
v_pk_fma_f32 v[212:213], v[212:213], v[170:171], v[170:171] op_sel:[0,1,0] op_sel_hi:[1,1,0]
s_add_u32 m0, s4, 73728
s_add_u32 s5, s67, 73728
buffer_load_dwordx4 v6, s[32:35], s5 offen sc1 lds
v_pk_mul_f32 v[212:213], v[212:213], v[180:181]
v_pk_mul_f32 v[214:215], v[182:183], v[182:183]
v_pk_fma_f32 v[214:215], v[214:215], v[170:171], v[170:171] op_sel:[0,1,0] op_sel_hi:[1,1,0]
v_pk_mul_f32 v[214:215], v[214:215], v[182:183]
v_pk_mul_f32 v[216:217], v[184:185], v[184:185]
v_pk_fma_f32 v[216:217], v[216:217], v[170:171], v[170:171] op_sel:[0,1,0] op_sel_hi:[1,1,0]
v_pk_mul_f32 v[216:217], v[216:217], v[184:185]
s_add_u32 m0, s4, 77824
s_add_u32 s5, s67, 77824
buffer_load_dwordx4 v6, s[32:35], s5 offen sc1 lds
v_pk_mul_f32 v[218:219], v[186:187], v[186:187]
v_pk_fma_f32 v[218:219], v[218:219], v[170:171], v[170:171] op_sel:[0,1,0] op_sel_hi:[1,1,0]
v_pk_mul_f32 v[218:219], v[218:219], v[186:187]
v_exp_f32 v204, v204
v_exp_f32 v205, v205
v_exp_f32 v206, v206
v_exp_f32 v207, v207
s_add_u32 m0, s4, 92160
s_add_u32 s5, s67, 81920
buffer_load_dwordx4 v6, s[32:35], s5 offen sc1 lds
v_exp_f32 v208, v208
v_exp_f32 v209, v209
v_exp_f32 v210, v210
v_exp_f32 v211, v211
v_exp_f32 v212, v212
v_exp_f32 v213, v213
v_exp_f32 v214, v214
s_add_u32 m0, s4, 96256
s_add_u32 s5, s67, 86016
buffer_load_dwordx4 v6, s[32:35], s5 offen sc1 lds
v_exp_f32 v215, v215
v_exp_f32 v216, v216
v_exp_f32 v217, v217
v_exp_f32 v218, v218
v_exp_f32 v219, v219
v_pk_add_f32 v[204:205], v[204:205], 1.0 op_sel_hi:[1,0]
v_pk_add_f32 v[206:207], v[206:207], 1.0 op_sel_hi:[1,0]
s_mov_b32 m0, 0x30000
s_mov_b32 s5, 90112
s_sub_u32 s6, s40, 0
s_cmp_lt_u32 s6, 2
s_cselect_b32 s5, 90112, s5
s_add_u32 s6, s4, 100352
s_sub_u32 s7, s40, 0
s_cmp_lt_u32 s7, 2
s_cselect_b32 m0, s6, m0
s_add_u32 s5, s5, s67
buffer_load_dwordx4 v6, s[32:35], s5 offen sc1 lds
v_pk_add_f32 v[208:209], v[208:209], 1.0 op_sel_hi:[1,0]
v_pk_add_f32 v[210:211], v[210:211], 1.0 op_sel_hi:[1,0]
v_pk_add_f32 v[212:213], v[212:213], 1.0 op_sel_hi:[1,0]
v_pk_add_f32 v[214:215], v[214:215], 1.0 op_sel_hi:[1,0]
v_pk_add_f32 v[216:217], v[216:217], 1.0 op_sel_hi:[1,0]
v_pk_add_f32 v[218:219], v[218:219], 1.0 op_sel_hi:[1,0]
v_rcp_f32 v204, v204
v_rcp_f32 v205, v205
v_rcp_f32 v206, v206
v_rcp_f32 v207, v207
v_rcp_f32 v208, v208
v_rcp_f32 v209, v209
v_rcp_f32 v210, v210
v_rcp_f32 v211, v211
v_rcp_f32 v212, v212
v_rcp_f32 v213, v213
v_rcp_f32 v214, v214
v_rcp_f32 v215, v215
v_rcp_f32 v216, v216
v_rcp_f32 v217, v217
v_rcp_f32 v218, v218
v_rcp_f32 v219, v219
v_pk_mul_f32 v[204:205], v[204:205], v[172:173]
v_pk_mul_f32 v[206:207], v[206:207], v[174:175]
v_pk_mul_f32 v[208:209], v[208:209], v[176:177]
v_pk_mul_f32 v[210:211], v[210:211], v[178:179]
v_pk_mul_f32 v[212:213], v[212:213], v[180:181]
v_pk_mul_f32 v[214:215], v[214:215], v[182:183]
v_pk_mul_f32 v[216:217], v[216:217], v[184:185]
v_pk_mul_f32 v[218:219], v[218:219], v[186:187]
v_cvt_pk_bf16_f32 v228, v204, v205
v_cvt_pk_bf16_f32 v229, v206, v207
v_cvt_pk_bf16_f32 v230, v208, v209
v_cvt_pk_bf16_f32 v231, v210, v211
v_cvt_pk_bf16_f32 v232, v212, v213
v_cvt_pk_bf16_f32 v233, v214, v215
v_cvt_pk_bf16_f32 v234, v216, v217
v_cvt_pk_bf16_f32 v235, v218, v219
buffer_store_dwordx4 v[228:231], v168, s[32:35], s56 offen offset:1024 sc1
buffer_store_dwordx4 v[232:235], v168, s[32:35], s56 offen offset:1536 sc1
ds_read_b128 v[172:175], v15 offset:768
ds_read_b128 v[188:191], v15 offset:1280
ds_read_b128 v[176:179], v15 offset:800
ds_read_b128 v[192:195], v15 offset:1312
ds_read_b128 v[180:183], v15 offset:832
ds_read_b128 v[196:199], v15 offset:1344
ds_read_b128 v[184:187], v15 offset:864
ds_read_b128 v[200:203], v15 offset:1376
s_waitcnt lgkmcnt(0)
v_pk_fma_f32 v[172:173], v[12:13], v[172:173], v[96:97] op_sel_hi:[0,1,1]
v_pk_fma_f32 v[172:173], v[172:173], v[12:13], v[188:189] op_sel:[0,1,0] op_sel_hi:[1,1,1]
v_pk_fma_f32 v[174:175], v[12:13], v[174:175], v[98:99] op_sel_hi:[0,1,1]
v_pk_fma_f32 v[174:175], v[174:175], v[12:13], v[190:191] op_sel:[0,1,0] op_sel_hi:[1,1,1]
v_pk_fma_f32 v[176:177], v[12:13], v[176:177], v[100:101] op_sel_hi:[0,1,1]
v_pk_fma_f32 v[176:177], v[176:177], v[12:13], v[192:193] op_sel:[0,1,0] op_sel_hi:[1,1,1]
v_pk_fma_f32 v[178:179], v[12:13], v[178:179], v[102:103] op_sel_hi:[0,1,1]
s_cmp_eq_u32 s83, 1
s_nop 3
s_cbranch_scc0 Lsa_59
s_waitcnt vmcnt(11)
s_lshr_b32 s91, s87, 4
s_add_u32 s91, s91, 4
s_mov_b64 exec, 1
v_mov_b32 v240, s3
v_mov_b32 v241, s91
global_store_dword v240, v241, s[30:31]
s_mov_b64 exec, -1
s_nop 2
Lsa_59:
v_pk_fma_f32 v[178:179], v[178:179], v[12:13], v[194:195] op_sel:[0,1,0] op_sel_hi:[1,1,1]
v_pk_fma_f32 v[180:181], v[12:13], v[180:181], v[104:105] op_sel_hi:[0,1,1]
v_pk_fma_f32 v[180:181], v[180:181], v[12:13], v[196:197] op_sel:[0,1,0] op_sel_hi:[1,1,1]
v_pk_fma_f32 v[182:183], v[12:13], v[182:183], v[106:107] op_sel_hi:[0,1,1]
v_pk_fma_f32 v[182:183], v[182:183], v[12:13], v[198:199] op_sel:[0,1,0] op_sel_hi:[1,1,1]
v_pk_fma_f32 v[184:185], v[12:13], v[184:185], v[108:109] op_sel_hi:[0,1,1]
v_pk_fma_f32 v[184:185], v[184:185], v[12:13], v[200:201] op_sel:[0,1,0] op_sel_hi:[1,1,1]
v_pk_fma_f32 v[186:187], v[12:13], v[186:187], v[110:111] op_sel_hi:[0,1,1]
v_pk_fma_f32 v[186:187], v[186:187], v[12:13], v[202:203] op_sel:[0,1,0] op_sel_hi:[1,1,1]
v_pk_mul_f32 v[204:205], v[172:173], v[172:173]
v_pk_fma_f32 v[204:205], v[204:205], v[170:171], v[170:171] op_sel:[0,1,0] op_sel_hi:[1,1,0]
v_pk_mul_f32 v[204:205], v[204:205], v[172:173]
v_pk_mul_f32 v[206:207], v[174:175], v[174:175]
v_pk_fma_f32 v[206:207], v[206:207], v[170:171], v[170:171] op_sel:[0,1,0] op_sel_hi:[1,1,0]
v_pk_mul_f32 v[206:207], v[206:207], v[174:175]
v_pk_mul_f32 v[208:209], v[176:177], v[176:177]
v_pk_fma_f32 v[208:209], v[208:209], v[170:171], v[170:171] op_sel:[0,1,0] op_sel_hi:[1,1,0]
v_pk_mul_f32 v[208:209], v[208:209], v[176:177]
v_pk_mul_f32 v[210:211], v[178:179], v[178:179]
v_pk_fma_f32 v[210:211], v[210:211], v[170:171], v[170:171] op_sel:[0,1,0] op_sel_hi:[1,1,0]
v_pk_mul_f32 v[210:211], v[210:211], v[178:179]
v_pk_mul_f32 v[212:213], v[180:181], v[180:181]
v_pk_fma_f32 v[212:213], v[212:213], v[170:171], v[170:171] op_sel:[0,1,0] op_sel_hi:[1,1,0]
v_pk_mul_f32 v[212:213], v[212:213], v[180:181]
v_pk_mul_f32 v[214:215], v[182:183], v[182:183]
v_pk_fma_f32 v[214:215], v[214:215], v[170:171], v[170:171] op_sel:[0,1,0] op_sel_hi:[1,1,0]
v_pk_mul_f32 v[214:215], v[214:215], v[182:183]
v_pk_mul_f32 v[216:217], v[184:185], v[184:185]
v_pk_fma_f32 v[216:217], v[216:217], v[170:171], v[170:171] op_sel:[0,1,0] op_sel_hi:[1,1,0]
v_pk_mul_f32 v[216:217], v[216:217], v[184:185]
v_pk_mul_f32 v[218:219], v[186:187], v[186:187]
v_pk_fma_f32 v[218:219], v[218:219], v[170:171], v[170:171] op_sel:[0,1,0] op_sel_hi:[1,1,0]
v_pk_mul_f32 v[218:219], v[218:219], v[186:187]
v_exp_f32 v204, v204
v_exp_f32 v205, v205
v_exp_f32 v206, v206
v_exp_f32 v207, v207
v_exp_f32 v208, v208
v_exp_f32 v209, v209
v_exp_f32 v210, v210
v_exp_f32 v211, v211
v_exp_f32 v212, v212
v_exp_f32 v213, v213
v_exp_f32 v214, v214
v_exp_f32 v215, v215
v_exp_f32 v216, v216
v_exp_f32 v217, v217
v_exp_f32 v218, v218
v_exp_f32 v219, v219
v_pk_add_f32 v[204:205], v[204:205], 1.0 op_sel_hi:[1,0]
v_pk_add_f32 v[206:207], v[206:207], 1.0 op_sel_hi:[1,0]
v_pk_add_f32 v[208:209], v[208:209], 1.0 op_sel_hi:[1,0]
v_pk_add_f32 v[210:211], v[210:211], 1.0 op_sel_hi:[1,0]
v_pk_add_f32 v[212:213], v[212:213], 1.0 op_sel_hi:[1,0]
v_pk_add_f32 v[214:215], v[214:215], 1.0 op_sel_hi:[1,0]
v_pk_add_f32 v[216:217], v[216:217], 1.0 op_sel_hi:[1,0]
v_pk_add_f32 v[218:219], v[218:219], 1.0 op_sel_hi:[1,0]
v_rcp_f32 v204, v204
v_rcp_f32 v205, v205
v_rcp_f32 v206, v206
v_rcp_f32 v207, v207
v_rcp_f32 v208, v208
v_rcp_f32 v209, v209
v_rcp_f32 v210, v210
v_rcp_f32 v211, v211
v_rcp_f32 v212, v212
v_rcp_f32 v213, v213
v_rcp_f32 v214, v214
v_rcp_f32 v215, v215
v_rcp_f32 v216, v216
v_rcp_f32 v217, v217
v_rcp_f32 v218, v218
v_rcp_f32 v219, v219
v_pk_mul_f32 v[204:205], v[204:205], v[172:173]
v_pk_mul_f32 v[206:207], v[206:207], v[174:175]
v_pk_mul_f32 v[208:209], v[208:209], v[176:177]
v_pk_mul_f32 v[210:211], v[210:211], v[178:179]
v_pk_mul_f32 v[212:213], v[212:213], v[180:181]
v_pk_mul_f32 v[214:215], v[214:215], v[182:183]
v_pk_mul_f32 v[216:217], v[216:217], v[184:185]
v_pk_mul_f32 v[218:219], v[218:219], v[186:187]
v_cvt_pk_bf16_f32 v220, v204, v205
v_cvt_pk_bf16_f32 v221, v206, v207
v_cvt_pk_bf16_f32 v222, v208, v209
v_cvt_pk_bf16_f32 v223, v210, v211
v_cvt_pk_bf16_f32 v224, v212, v213
v_cvt_pk_bf16_f32 v225, v214, v215
v_cvt_pk_bf16_f32 v226, v216, v217
v_cvt_pk_bf16_f32 v227, v218, v219
s_lshl_b32 s91, s41, 8
s_add_u32 s91, s91, 16384
v_lshlrev_b32 v240, 2, v1
v_add_u32 v240, s91, v240
global_load_dword v241, v240, s[30:31] sc1
buffer_store_dwordx4 v[220:223], v168, s[32:35], s56 offen offset:2048 sc1
buffer_store_dwordx4 v[224:227], v168, s[32:35], s56 offen offset:2560 sc1
s_cmp_eq_u32 s83, 1
s_nop 0
s_cbranch_scc0 Lss_60
s_waitcnt vmcnt(2)
s_lshr_b32 s91, s87, 4
s_add_u32 s91, s91, 4
v_cmp_gt_u32 vcc, s91, v241
s_nop 4
s_cbranch_vccz Lse_61
v_mov_b32 v244, v240
s_cmp_eq_u32 s53, 0
s_cselect_b32 s82, 0, 6000000
s_nop 2
Lq_63:
global_load_dword v245, v244, s[30:31] sc1
s_add_u32 s82, s82, 1
s_cmp_gt_u32 s82, 6000000
s_cbranch_scc1 Lqd_64_to
s_waitcnt vmcnt(0)
v_cmp_gt_u32 vcc, s91, v245
s_nop 4
s_cbranch_vccz Lqd_64
s_branch Lq_63
Lqd_64_to:
s_or_b32 s53, s53, 64
s_waitcnt vmcnt(0)
Lqd_64:
s_branch Lse_61
Lss_60:
s_waitcnt vmcnt(0)
s_barrier
s_cmp_eq_u32 s40, 0
s_cbranch_scc0 Lsk_62
s_mov_b64 exec, 1
v_mov_b32 v244, s84
global_atomic_add v244, v11, s[30:31] sc1
s_mov_b64 exec, -1
s_nop 2
Lsk_62:
s_cmp_eq_u32 s40, 1
s_cbranch_scc0 Lsp_65
s_add_u32 s91, s87, 64
v_mov_b32 v168, s84
v_mov_b32 v169, s91
v_mov_b32 v171, 0xff
s_mov_b64 exec, 1
s_cmp_eq_u32 s53, 0
s_cselect_b32 s82, 0, 6000000
s_nop 1
Lp_66:
global_load_dword v170, v168, s[30:31] sc1
s_add_u32 s82, s82, 1
s_cmp_gt_u32 s82, 6000000
s_cbranch_scc1 Lpd_67_to
s_waitcnt vmcnt(0)
v_and_b32 v172, v171, v170
v_cmp_lt_u32 vcc, v172, v169
s_nop 4
s_cbranch_vccz Lpd_67
s_branch Lp_66
Lpd_67_to:
s_or_b32 s53, s53, 64
s_waitcnt vmcnt(0)
Lpd_67:
s_mov_b64 exec, -1
Lsp_65:
s_barrier
Lse_61:
s_cmp_eq_u32 s47, 1
s_cselect_b32 s64, 0x40000000, s64
s_lshl_b32 s56, s8, 23
s_add_u32 s56, s56, 41943040
s_mul_i32 s57, s41, 393216
s_add_u32 s56, s56, s57
s_lshl_b32 s57, s43, 1
s_add_u32 s57, s57, s45
s_mul_i32 s57, s57, 98304
s_add_u32 s56, s56, s57
s_mul_i32 s57, s46, 24576
s_add_u32 s56, s56, s57
s_add_u32 s57, s56, 49152
buffer_load_dwordx4 a[0:3], v6, s[32:35], s56 offen sc1
buffer_load_dwordx4 a[96:99], v6, s[32:35], s57 offen sc1
buffer_load_dwordx4 a[4:7], v6, s[32:35], s56 offen offset:3072 sc1
buffer_load_dwordx4 a[100:103], v6, s[32:35], s57 offen offset:3072 sc1
s_add_u32 s56, s56, 4096
buffer_load_dwordx4 a[8:11], v6, s[32:35], s56 offen offset:2048 sc1
s_add_u32 s57, s57, 4096
buffer_load_dwordx4 a[104:107], v6, s[32:35], s57 offen offset:2048 sc1
s_add_u32 s56, s56, 4096
buffer_load_dwordx4 a[12:15], v6, s[32:35], s56 offen offset:1024 sc1
s_add_u32 s57, s57, 4096
buffer_load_dwordx4 a[108:111], v6, s[32:35], s57 offen offset:1024 sc1
s_add_u32 s56, s56, 4096
buffer_load_dwordx4 a[16:19], v6, s[32:35], s56 offen sc1
s_add_u32 s57, s57, 4096
buffer_load_dwordx4 a[112:115], v6, s[32:35], s57 offen sc1
s_lshl_b32 s91, s41, 8
s_add_u32 s91, s91, 24576
v_lshlrev_b32 v172, 2, v1
v_add_u32 v172, s91, v172
s_add_u32 s60, s3, 8192
v_mov_b32 v174, s60
s_add_u32 s60, s47, 1
v_mov_b32 v175, s60
s_cmp_eq_u32 s83, 1
s_cselect_b32 s60, s60, 0
s_mul_i32 s58, s46, 5120
s_add_u32 s58, s58, 81920
v_add_u32 v56, s58, v6
s_waitcnt vmcnt(8)
s_mov_b64 exec, 1
global_store_dword v174, v175, s[30:31]
s_mov_b64 exec, -1
s_barrier
ds_read_b128 v[128:131], v56 offset:0
ds_read_b128 v[132:135], v56 offset:1024
ds_read_b128 v[136:139], v56 offset:2048
ds_read_b128 v[140:143], v56 offset:3072
ds_read_b128 v[144:147], v56 offset:4096
v_add_u32 v56, -71680, v56
ds_read_b128 v[148:151], v56 offset:0
ds_read_b128 v[152:155], v56 offset:1024
ds_read_b128 v[156:159], v56 offset:2048
ds_read_b128 v[160:163], v56 offset:3072
ds_read_b128 v[164:167], v56 offset:4096
s_waitcnt lgkmcnt(9)
v_mfma_f32_16x16x32_bf16 v[64:67], v[128:131], a[0:3], 0
v_mfma_f32_16x16x32_bf16 v[68:71], v[128:131], a[96:99], 0
buffer_load_dwordx4 a[20:23], v6, s[32:35], s56 offen offset:3072 sc1
s_waitcnt lgkmcnt(8)
v_mfma_f32_16x16x32_bf16 v[72:75], v[132:135], a[0:3], 0
v_mfma_f32_16x16x32_bf16 v[76:79], v[132:135], a[96:99], 0
buffer_load_dwordx4 a[116:119], v6, s[32:35], s57 offen offset:3072 sc1
s_waitcnt lgkmcnt(7)
v_mfma_f32_16x16x32_bf16 v[80:83], v[136:139], a[0:3], 0
v_mfma_f32_16x16x32_bf16 v[84:87], v[136:139], a[96:99], 0
s_add_u32 s56, s56, 4096
buffer_load_dwordx4 a[24:27], v6, s[32:35], s56 offen offset:2048 sc1
s_waitcnt lgkmcnt(6)
v_mfma_f32_16x16x32_bf16 v[88:91], v[140:143], a[0:3], 0
v_mfma_f32_16x16x32_bf16 v[92:95], v[140:143], a[96:99], 0
s_waitcnt lgkmcnt(5)
v_mfma_f32_16x16x32_bf16 v[96:99], v[144:147], a[0:3], 0
v_mfma_f32_16x16x32_bf16 v[100:103], v[144:147], a[96:99], 0
ds_read_b128 v[128:131], v56 offset:10240
ds_read_b128 v[132:135], v56 offset:11264
ds_read_b128 v[136:139], v56 offset:12288
ds_read_b128 v[140:143], v56 offset:13312
ds_read_b128 v[144:147], v56 offset:14336
s_waitcnt vmcnt(10)
s_waitcnt lgkmcnt(9)
v_mfma_f32_16x16x32_bf16 v[64:67], v[148:151], a[4:7], v[64:67]
v_mfma_f32_16x16x32_bf16 v[68:71], v[148:151], a[100:103], v[68:71]
s_add_u32 s57, s57, 4096
buffer_load_dwordx4 a[120:123], v6, s[32:35], s57 offen offset:2048 sc1
s_waitcnt lgkmcnt(8)
v_mfma_f32_16x16x32_bf16 v[72:75], v[152:155], a[4:7], v[72:75]
v_mfma_f32_16x16x32_bf16 v[76:79], v[152:155], a[100:103], v[76:79]
s_waitcnt lgkmcnt(7)
v_mfma_f32_16x16x32_bf16 v[80:83], v[156:159], a[4:7], v[80:83]
v_mfma_f32_16x16x32_bf16 v[84:87], v[156:159], a[100:103], v[84:87]
s_add_u32 s56, s56, 4096
buffer_load_dwordx4 a[28:31], v6, s[32:35], s56 offen offset:1024 sc1
s_waitcnt lgkmcnt(6)
v_mfma_f32_16x16x32_bf16 v[88:91], v[160:163], a[4:7], v[88:91]
v_mfma_f32_16x16x32_bf16 v[92:95], v[160:163], a[100:103], v[92:95]
s_waitcnt lgkmcnt(5)
v_mfma_f32_16x16x32_bf16 v[96:99], v[164:167], a[4:7], v[96:99]
v_mfma_f32_16x16x32_bf16 v[100:103], v[164:167], a[100:103], v[100:103]
ds_read_b128 v[148:151], v56 offset:20480
ds_read_b128 v[152:155], v56 offset:21504
ds_read_b128 v[156:159], v56 offset:22528
ds_read_b128 v[160:163], v56 offset:23552
ds_read_b128 v[164:167], v56 offset:24576
global_load_dword v173, v172, s[30:31] sc1
s_waitcnt vmcnt(11)
s_waitcnt lgkmcnt(9)
v_mfma_f32_16x16x32_bf16 v[64:67], v[128:131], a[8:11], v[64:67]
v_mfma_f32_16x16x32_bf16 v[68:71], v[128:131], a[104:107], v[68:71]
s_add_u32 s57, s57, 4096
buffer_load_dwordx4 a[124:127], v6, s[32:35], s57 offen offset:1024 sc1
s_waitcnt lgkmcnt(8)
v_mfma_f32_16x16x32_bf16 v[72:75], v[132:135], a[8:11], v[72:75]
v_mfma_f32_16x16x32_bf16 v[76:79], v[132:135], a[104:107], v[76:79]
s_waitcnt lgkmcnt(7)
v_mfma_f32_16x16x32_bf16 v[80:83], v[136:139], a[8:11], v[80:83]
v_mfma_f32_16x16x32_bf16 v[84:87], v[136:139], a[104:107], v[84:87]
s_waitcnt lgkmcnt(6)
v_mfma_f32_16x16x32_bf16 v[88:91], v[140:143], a[8:11], v[88:91]
v_mfma_f32_16x16x32_bf16 v[92:95], v[140:143], a[104:107], v[92:95]
s_waitcnt lgkmcnt(5)
v_mfma_f32_16x16x32_bf16 v[96:99], v[144:147], a[8:11], v[96:99]
v_mfma_f32_16x16x32_bf16 v[100:103], v[144:147], a[104:107], v[100:103]
ds_read_b128 v[128:131], v56 offset:30720
ds_read_b128 v[132:135], v56 offset:31744
ds_read_b128 v[136:139], v56 offset:32768
ds_read_b128 v[140:143], v56 offset:33792
ds_read_b128 v[144:147], v56 offset:34816
s_waitcnt vmcnt(10)
s_waitcnt lgkmcnt(9)
v_mfma_f32_16x16x32_bf16 v[64:67], v[148:151], a[12:15], v[64:67]
v_mfma_f32_16x16x32_bf16 v[68:71], v[148:151], a[108:111], v[68:71]
s_waitcnt lgkmcnt(8)
v_mfma_f32_16x16x32_bf16 v[72:75], v[152:155], a[12:15], v[72:75]
v_mfma_f32_16x16x32_bf16 v[76:79], v[152:155], a[108:111], v[76:79]
s_waitcnt lgkmcnt(7)
v_mfma_f32_16x16x32_bf16 v[80:83], v[156:159], a[12:15], v[80:83]
v_mfma_f32_16x16x32_bf16 v[84:87], v[156:159], a[108:111], v[84:87]
s_waitcnt lgkmcnt(6)
v_mfma_f32_16x16x32_bf16 v[88:91], v[160:163], a[12:15], v[88:91]
v_mfma_f32_16x16x32_bf16 v[92:95], v[160:163], a[108:111], v[92:95]
s_waitcnt lgkmcnt(5)
v_mfma_f32_16x16x32_bf16 v[96:99], v[164:167], a[12:15], v[96:99]
v_mfma_f32_16x16x32_bf16 v[100:103], v[164:167], a[108:111], v[100:103]
ds_read_b128 v[148:151], v56 offset:40960
ds_read_b128 v[152:155], v56 offset:41984
ds_read_b128 v[156:159], v56 offset:43008
ds_read_b128 v[160:163], v56 offset:44032
ds_read_b128 v[164:167], v56 offset:45056
s_waitcnt vmcnt(1)
v_cmp_gt_u32 vcc, s60, v173
s_nop 4
s_cbranch_vccz Lfb_68
s_cmp_eq_u32 s53, 0
s_cselect_b32 s82, 0, 6000000
Lq_69:
global_load_dword v173, v172, s[30:31] sc1
s_add_u32 s82, s82, 1
s_cmp_gt_u32 s82, 6000000
s_cbranch_scc1 Lqd_70_to
s_waitcnt vmcnt(0)
v_cmp_gt_u32 vcc, s60, v173
s_nop 4
s_cbranch_vccz Lqd_70
s_branch Lq_69
Lqd_70_to:
s_or_b32 s53, s53, 64
s_waitcnt vmcnt(0)
Lqd_70:
Lfb_68:
s_waitcnt lgkmcnt(9)
v_mfma_f32_16x16x32_bf16 v[64:67], v[128:131], a[16:19], v[64:67]
v_mfma_f32_16x16x32_bf16 v[68:71], v[128:131], a[112:115], v[68:71]
s_add_u32 s56, s56, 4294946816
buffer_load_dwordx4 a[32:35], v6, s[32:35], s56 offen offset:1024 sc1
s_waitcnt lgkmcnt(8)
v_mfma_f32_16x16x32_bf16 v[72:75], v[132:135], a[16:19], v[72:75]
v_mfma_f32_16x16x32_bf16 v[76:79], v[132:135], a[112:115], v[76:79]
s_add_u32 s57, s57, 4294946816
buffer_load_dwordx4 a[128:131], v6, s[32:35], s57 offen offset:1024 sc1
s_waitcnt lgkmcnt(7)
v_mfma_f32_16x16x32_bf16 v[80:83], v[136:139], a[16:19], v[80:83]
v_mfma_f32_16x16x32_bf16 v[84:87], v[136:139], a[112:115], v[84:87]
s_add_u32 s56, s56, 4096
buffer_load_dwordx4 a[36:39], v6, s[32:35], s56 offen sc1
s_waitcnt lgkmcnt(6)
v_mfma_f32_16x16x32_bf16 v[88:91], v[140:143], a[16:19], v[88:91]
v_mfma_f32_16x16x32_bf16 v[92:95], v[140:143], a[112:115], v[92:95]
s_add_u32 s57, s57, 4096
buffer_load_dwordx4 a[132:135], v6, s[32:35], s57 offen sc1
s_waitcnt lgkmcnt(5)
v_mfma_f32_16x16x32_bf16 v[96:99], v[144:147], a[16:19], v[96:99]
v_mfma_f32_16x16x32_bf16 v[100:103], v[144:147], a[112:115], v[100:103]
ds_read_b128 v[128:131], v56 offset:51200
ds_read_b128 v[132:135], v56 offset:52224
ds_read_b128 v[136:139], v56 offset:53248
ds_read_b128 v[140:143], v56 offset:54272
ds_read_b128 v[144:147], v56 offset:55296
s_barrier
s_waitcnt lgkmcnt(9)
v_mfma_f32_16x16x32_bf16 v[64:67], v[148:151], a[20:23], v[64:67]
v_mfma_f32_16x16x32_bf16 v[68:71], v[148:151], a[116:119], v[68:71]
buffer_load_dwordx4 a[40:43], v6, s[32:35], s56 offen offset:3072 sc1
s_waitcnt lgkmcnt(8)
v_mfma_f32_16x16x32_bf16 v[72:75], v[152:155], a[20:23], v[72:75]
v_mfma_f32_16x16x32_bf16 v[76:79], v[152:155], a[116:119], v[76:79]
buffer_load_dwordx4 a[136:139], v6, s[32:35], s57 offen offset:3072 sc1
s_add_u32 m0, s4, 81920
s_add_u32 s5, s67, 153600
buffer_load_dwordx4 v6, s[32:35], s5 offen sc1 lds
s_waitcnt lgkmcnt(7)
v_mfma_f32_16x16x32_bf16 v[80:83], v[156:159], a[20:23], v[80:83]
v_mfma_f32_16x16x32_bf16 v[84:87], v[156:159], a[116:119], v[84:87]
s_add_u32 s56, s56, 4096
buffer_load_dwordx4 a[44:47], v6, s[32:35], s56 offen offset:2048 sc1
s_waitcnt lgkmcnt(6)
v_mfma_f32_16x16x32_bf16 v[88:91], v[160:163], a[20:23], v[88:91]
v_mfma_f32_16x16x32_bf16 v[92:95], v[160:163], a[116:119], v[92:95]
s_add_u32 m0, s4, 86016
s_add_u32 s5, s67, 157696
buffer_load_dwordx4 v6, s[32:35], s5 offen sc1 lds
s_waitcnt lgkmcnt(5)
v_mfma_f32_16x16x32_bf16 v[96:99], v[164:167], a[20:23], v[96:99]
v_mfma_f32_16x16x32_bf16 v[100:103], v[164:167], a[116:119], v[100:103]
s_mov_b32 m0, 0x30000
s_mov_b32 s5, 161792
s_sub_u32 s6, s40, 0
s_cmp_lt_u32 s6, 2
s_cselect_b32 s5, 161792, s5
s_add_u32 s6, s4, 90112
s_sub_u32 s7, s40, 0
s_cmp_lt_u32 s7, 2
s_cselect_b32 m0, s6, m0
s_sub_u32 s6, s40, 2
s_cmp_lt_u32 s6, 2
s_cselect_b32 s5, 161792, s5
s_add_u32 s6, s4, 8192
s_sub_u32 s7, s40, 2
s_cmp_lt_u32 s7, 2
s_cselect_b32 m0, s6, m0
s_add_u32 s5, s5, s67
buffer_load_dwordx4 v6, s[32:35], s5 offen sc1 lds
ds_read_b128 v[148:151], v56 offset:61440
ds_read_b128 v[152:155], v56 offset:62464
ds_read_b128 v[156:159], v56 offset:63488
ds_read_b128 v[160:163], v56 offset:64512
v_add_u32 v56, 65536, v56
ds_read_b128 v[164:167], v56 offset:0
s_waitcnt lgkmcnt(9)
v_mfma_f32_16x16x32_bf16 v[64:67], v[128:131], a[24:27], v[64:67]
v_mfma_f32_16x16x32_bf16 v[68:71], v[128:131], a[120:123], v[68:71]
s_add_u32 s57, s57, 4096
buffer_load_dwordx4 a[140:143], v6, s[32:35], s57 offen offset:2048 sc1
s_waitcnt lgkmcnt(8)
v_mfma_f32_16x16x32_bf16 v[72:75], v[132:135], a[24:27], v[72:75]
v_mfma_f32_16x16x32_bf16 v[76:79], v[132:135], a[120:123], v[76:79]
s_add_u32 m0, s4, 12288
s_add_u32 s5, s67, 165888
buffer_load_dwordx4 v6, s[32:35], s5 offen sc1 lds
s_waitcnt lgkmcnt(7)
v_mfma_f32_16x16x32_bf16 v[80:83], v[136:139], a[24:27], v[80:83]
v_mfma_f32_16x16x32_bf16 v[84:87], v[136:139], a[120:123], v[84:87]
s_add_u32 s56, s56, 4096
buffer_load_dwordx4 a[48:51], v6, s[32:35], s56 offen offset:1024 sc1
s_waitcnt lgkmcnt(6)
v_mfma_f32_16x16x32_bf16 v[88:91], v[140:143], a[24:27], v[88:91]
v_mfma_f32_16x16x32_bf16 v[92:95], v[140:143], a[120:123], v[92:95]
s_add_u32 m0, s4, 16384
s_add_u32 s5, s67, 169984
buffer_load_dwordx4 v6, s[32:35], s5 offen sc1 lds
s_waitcnt lgkmcnt(5)
v_mfma_f32_16x16x32_bf16 v[96:99], v[144:147], a[24:27], v[96:99]
v_mfma_f32_16x16x32_bf16 v[100:103], v[144:147], a[120:123], v[100:103]
s_add_u32 m0, s4, 20480
s_add_u32 s5, s67, 174080
buffer_load_dwordx4 v6, s[32:35], s5 offen sc1 lds
ds_read_b128 v[128:131], v56 offset:16384
ds_read_b128 v[132:135], v56 offset:17408
ds_read_b128 v[136:139], v56 offset:18432
ds_read_b128 v[140:143], v56 offset:19456
ds_read_b128 v[144:147], v56 offset:20480
s_waitcnt vmcnt(15)
s_waitcnt lgkmcnt(9)
v_mfma_f32_16x16x32_bf16 v[64:67], v[148:151], a[28:31], v[64:67]
v_mfma_f32_16x16x32_bf16 v[68:71], v[148:151], a[124:127], v[68:71]
s_add_u32 s57, s57, 4096
buffer_load_dwordx4 a[144:147], v6, s[32:35], s57 offen offset:1024 sc1
s_waitcnt lgkmcnt(8)
v_mfma_f32_16x16x32_bf16 v[72:75], v[152:155], a[28:31], v[72:75]
v_mfma_f32_16x16x32_bf16 v[76:79], v[152:155], a[124:127], v[76:79]
s_add_u32 m0, s4, 24576
s_add_u32 s5, s67, 178176
buffer_load_dwordx4 v6, s[32:35], s5 offen sc1 lds
s_waitcnt lgkmcnt(7)
v_mfma_f32_16x16x32_bf16 v[80:83], v[156:159], a[28:31], v[80:83]
v_mfma_f32_16x16x32_bf16 v[84:87], v[156:159], a[124:127], v[84:87]
s_add_u32 s56, s56, 4096
buffer_load_dwordx4 a[52:55], v6, s[32:35], s56 offen sc1
s_waitcnt lgkmcnt(6)
v_mfma_f32_16x16x32_bf16 v[88:91], v[160:163], a[28:31], v[88:91]
v_mfma_f32_16x16x32_bf16 v[92:95], v[160:163], a[124:127], v[92:95]
s_add_u32 m0, s4, 28672
s_add_u32 s5, s67, 182272
buffer_load_dwordx4 v6, s[32:35], s5 offen sc1 lds
s_waitcnt lgkmcnt(5)
v_mfma_f32_16x16x32_bf16 v[96:99], v[164:167], a[28:31], v[96:99]
v_mfma_f32_16x16x32_bf16 v[100:103], v[164:167], a[124:127], v[100:103]
s_add_u32 m0, s4, 32768
s_add_u32 s5, s67, 186368
buffer_load_dwordx4 v6, s[32:35], s5 offen sc1 lds
ds_read_b128 v[148:151], v56 offset:26624
ds_read_b128 v[152:155], v56 offset:27648
ds_read_b128 v[156:159], v56 offset:28672
ds_read_b128 v[160:163], v56 offset:29696
ds_read_b128 v[164:167], v56 offset:30720
s_waitcnt vmcnt(18)
s_waitcnt lgkmcnt(9)
v_mfma_f32_16x16x32_bf16 v[64:67], v[128:131], a[32:35], v[64:67]
v_mfma_f32_16x16x32_bf16 v[68:71], v[128:131], a[128:131], v[68:71]
s_add_u32 s57, s57, 4096
buffer_load_dwordx4 a[148:151], v6, s[32:35], s57 offen sc1
s_waitcnt lgkmcnt(8)
v_mfma_f32_16x16x32_bf16 v[72:75], v[132:135], a[32:35], v[72:75]
v_mfma_f32_16x16x32_bf16 v[76:79], v[132:135], a[128:131], v[76:79]
s_add_u32 m0, s4, 36864
s_add_u32 s5, s67, 190464
buffer_load_dwordx4 v6, s[32:35], s5 offen sc1 lds
s_waitcnt lgkmcnt(7)
v_mfma_f32_16x16x32_bf16 v[80:83], v[136:139], a[32:35], v[80:83]
v_mfma_f32_16x16x32_bf16 v[84:87], v[136:139], a[128:131], v[84:87]
buffer_load_dwordx4 a[56:59], v6, s[32:35], s56 offen offset:3072 sc1
s_waitcnt lgkmcnt(6)
v_mfma_f32_16x16x32_bf16 v[88:91], v[140:143], a[32:35], v[88:91]
v_mfma_f32_16x16x32_bf16 v[92:95], v[140:143], a[128:131], v[92:95]
s_add_u32 m0, s4, 40960
s_add_u32 s5, s67, 194560
buffer_load_dwordx4 v6, s[32:35], s5 offen sc1 lds
s_waitcnt lgkmcnt(5)
v_mfma_f32_16x16x32_bf16 v[96:99], v[144:147], a[32:35], v[96:99]
v_mfma_f32_16x16x32_bf16 v[100:103], v[144:147], a[128:131], v[100:103]
s_add_u32 m0, s4, 45056
s_add_u32 s5, s67, 198656
buffer_load_dwordx4 v6, s[32:35], s5 offen sc1 lds
ds_read_b128 v[128:131], v56 offset:36864
ds_read_b128 v[132:135], v56 offset:37888
ds_read_b128 v[136:139], v56 offset:38912
ds_read_b128 v[140:143], v56 offset:39936
ds_read_b128 v[144:147], v56 offset:40960
s_mov_b32 m0, 0x30000
s_mov_b32 s5, 202752
s_sub_u32 s6, s40, 0
s_cmp_lt_u32 s6, 2
s_cselect_b32 s5, 202752, s5
s_add_u32 s6, s4, 49152
s_sub_u32 s7, s40, 0
s_cmp_lt_u32 s7, 2
s_cselect_b32 m0, s6, m0
s_add_u32 s5, s5, s67
buffer_load_dwordx4 v6, s[32:35], s5 offen sc1 lds
s_barrier
s_waitcnt vmcnt(22)
s_waitcnt lgkmcnt(9)
v_mfma_f32_16x16x32_bf16 v[64:67], v[148:151], a[36:39], v[64:67]
v_mfma_f32_16x16x32_bf16 v[68:71], v[148:151], a[132:135], v[68:71]
buffer_load_dwordx4 a[152:155], v6, s[32:35], s57 offen offset:3072 sc1
s_waitcnt lgkmcnt(8)
v_mfma_f32_16x16x32_bf16 v[72:75], v[152:155], a[36:39], v[72:75]
v_mfma_f32_16x16x32_bf16 v[76:79], v[152:155], a[132:135], v[76:79]
s_add_u32 m0, s4, 51200
s_add_u32 s5, s67, 204800
buffer_load_dwordx4 v6, s[32:35], s5 offen sc1 lds
s_waitcnt lgkmcnt(7)
v_mfma_f32_16x16x32_bf16 v[80:83], v[156:159], a[36:39], v[80:83]
v_mfma_f32_16x16x32_bf16 v[84:87], v[156:159], a[132:135], v[84:87]
s_add_u32 s56, s56, 4096
buffer_load_dwordx4 a[60:63], v6, s[32:35], s56 offen offset:2048 sc1
s_waitcnt lgkmcnt(6)
v_mfma_f32_16x16x32_bf16 v[88:91], v[160:163], a[36:39], v[88:91]
v_mfma_f32_16x16x32_bf16 v[92:95], v[160:163], a[132:135], v[92:95]
s_add_u32 m0, s4, 55296
s_add_u32 s5, s67, 208896
buffer_load_dwordx4 v6, s[32:35], s5 offen sc1 lds
s_waitcnt lgkmcnt(5)
v_mfma_f32_16x16x32_bf16 v[96:99], v[164:167], a[36:39], v[96:99]
v_mfma_f32_16x16x32_bf16 v[100:103], v[164:167], a[132:135], v[100:103]
s_add_u32 m0, s4, 59392
s_add_u32 s5, s67, 212992
buffer_load_dwordx4 v6, s[32:35], s5 offen sc1 lds
ds_read_b128 v[148:151], v56 offset:47104
ds_read_b128 v[152:155], v56 offset:48128
ds_read_b128 v[156:159], v56 offset:49152
ds_read_b128 v[160:163], v56 offset:50176
ds_read_b128 v[164:167], v56 offset:51200
s_waitcnt vmcnt(25)
s_waitcnt lgkmcnt(9)
v_mfma_f32_16x16x32_bf16 v[64:67], v[128:131], a[40:43], v[64:67]
v_mfma_f32_16x16x32_bf16 v[68:71], v[128:131], a[136:139], v[68:71]
s_add_u32 s57, s57, 4096
buffer_load_dwordx4 a[156:159], v6, s[32:35], s57 offen offset:2048 sc1
s_waitcnt lgkmcnt(8)
v_mfma_f32_16x16x32_bf16 v[72:75], v[132:135], a[40:43], v[72:75]
v_mfma_f32_16x16x32_bf16 v[76:79], v[132:135], a[136:139], v[76:79]
s_add_u32 m0, s4, 63488
s_add_u32 s5, s67, 217088
buffer_load_dwordx4 v6, s[32:35], s5 offen sc1 lds
s_waitcnt lgkmcnt(7)
v_mfma_f32_16x16x32_bf16 v[80:83], v[136:139], a[40:43], v[80:83]
v_mfma_f32_16x16x32_bf16 v[84:87], v[136:139], a[136:139], v[84:87]
s_add_u32 s56, s56, 4294946816
buffer_load_dwordx4 a[64:67], v6, s[32:35], s56 offen offset:2048 sc1
s_waitcnt lgkmcnt(6)
v_mfma_f32_16x16x32_bf16 v[88:91], v[140:143], a[40:43], v[88:91]
v_mfma_f32_16x16x32_bf16 v[92:95], v[140:143], a[136:139], v[92:95]
s_add_u32 m0, s4, 67584
s_add_u32 s5, s67, 221184
buffer_load_dwordx4 v6, s[32:35], s5 offen sc1 lds
s_waitcnt lgkmcnt(5)
v_mfma_f32_16x16x32_bf16 v[96:99], v[144:147], a[40:43], v[96:99]
v_mfma_f32_16x16x32_bf16 v[100:103], v[144:147], a[136:139], v[100:103]
s_add_u32 m0, s4, 71680
s_add_u32 s5, s67, 225280
buffer_load_dwordx4 v6, s[32:35], s5 offen sc1 lds
ds_read_b128 v[128:131], v56 offset:57344
ds_read_b128 v[132:135], v56 offset:58368
ds_read_b128 v[136:139], v56 offset:59392
ds_read_b128 v[140:143], v56 offset:60416
ds_read_b128 v[144:147], v56 offset:61440
s_waitcnt vmcnt(25)
s_waitcnt lgkmcnt(9)
v_mfma_f32_16x16x32_bf16 v[64:67], v[148:151], a[44:47], v[64:67]
v_mfma_f32_16x16x32_bf16 v[68:71], v[148:151], a[140:143], v[68:71]
s_add_u32 s57, s57, 4294946816
buffer_load_dwordx4 a[160:163], v6, s[32:35], s57 offen offset:2048 sc1
s_waitcnt lgkmcnt(8)
v_mfma_f32_16x16x32_bf16 v[72:75], v[152:155], a[44:47], v[72:75]
v_mfma_f32_16x16x32_bf16 v[76:79], v[152:155], a[140:143], v[76:79]
s_add_u32 m0, s4, 75776
s_add_u32 s5, s67, 229376
buffer_load_dwordx4 v6, s[32:35], s5 offen sc1 lds
s_waitcnt lgkmcnt(7)
v_mfma_f32_16x16x32_bf16 v[80:83], v[156:159], a[44:47], v[80:83]
v_mfma_f32_16x16x32_bf16 v[84:87], v[156:159], a[140:143], v[84:87]
s_add_u32 s56, s56, 4096
buffer_load_dwordx4 a[68:71], v6, s[32:35], s56 offen offset:1024 sc1
s_waitcnt lgkmcnt(6)
v_mfma_f32_16x16x32_bf16 v[88:91], v[160:163], a[44:47], v[88:91]
v_mfma_f32_16x16x32_bf16 v[92:95], v[160:163], a[140:143], v[92:95]
s_mov_b32 m0, 0x30000
s_mov_b32 s5, 233472
s_sub_u32 s6, s40, 0
s_cmp_lt_u32 s6, 2
s_cselect_b32 s5, 233472, s5
s_add_u32 s6, s4, 79872
s_sub_u32 s7, s40, 0
s_cmp_lt_u32 s7, 2
s_cselect_b32 m0, s6, m0
s_sub_u32 s6, s40, 2
s_cmp_lt_u32 s6, 2
s_cselect_b32 s5, 233472, s5
s_add_u32 s6, s4, 90112
s_sub_u32 s7, s40, 2
s_cmp_lt_u32 s7, 2
s_cselect_b32 m0, s6, m0
s_add_u32 s5, s5, s67
buffer_load_dwordx4 v6, s[32:35], s5 offen sc1 lds
s_waitcnt lgkmcnt(5)
v_mfma_f32_16x16x32_bf16 v[96:99], v[164:167], a[44:47], v[96:99]
v_mfma_f32_16x16x32_bf16 v[100:103], v[164:167], a[140:143], v[100:103]
s_add_u32 m0, s4, 94208
s_add_u32 s5, s67, 237568
buffer_load_dwordx4 v6, s[32:35], s5 offen sc1 lds
v_add_u32 v56, 67584, v56
ds_read_b128 v[148:151], v56 offset:0
ds_read_b128 v[152:155], v56 offset:1024
ds_read_b128 v[156:159], v56 offset:2048
ds_read_b128 v[160:163], v56 offset:3072
ds_read_b128 v[164:167], v56 offset:4096
s_waitcnt vmcnt(25)
s_waitcnt lgkmcnt(9)
v_mfma_f32_16x16x32_bf16 v[64:67], v[128:131], a[48:51], v[64:67]
v_mfma_f32_16x16x32_bf16 v[68:71], v[128:131], a[144:147], v[68:71]
s_add_u32 s57, s57, 4096
buffer_load_dwordx4 a[164:167], v6, s[32:35], s57 offen offset:1024 sc1
s_waitcnt lgkmcnt(8)
v_mfma_f32_16x16x32_bf16 v[72:75], v[132:135], a[48:51], v[72:75]
v_mfma_f32_16x16x32_bf16 v[76:79], v[132:135], a[144:147], v[76:79]
s_add_u32 m0, s4, 98304
s_add_u32 s5, s67, 241664
buffer_load_dwordx4 v6, s[32:35], s5 offen sc1 lds
s_waitcnt lgkmcnt(7)
v_mfma_f32_16x16x32_bf16 v[80:83], v[136:139], a[48:51], v[80:83]
v_mfma_f32_16x16x32_bf16 v[84:87], v[136:139], a[144:147], v[84:87]
s_add_u32 s56, s56, 4096
buffer_load_dwordx4 a[72:75], v6, s[32:35], s56 offen sc1
s_waitcnt lgkmcnt(6)
v_mfma_f32_16x16x32_bf16 v[88:91], v[140:143], a[48:51], v[88:91]
v_mfma_f32_16x16x32_bf16 v[92:95], v[140:143], a[144:147], v[92:95]
s_waitcnt lgkmcnt(5)
v_mfma_f32_16x16x32_bf16 v[96:99], v[144:147], a[48:51], v[96:99]
v_mfma_f32_16x16x32_bf16 v[100:103], v[144:147], a[144:147], v[100:103]
ds_read_b128 v[128:131], v56 offset:10240
ds_read_b128 v[132:135], v56 offset:11264
ds_read_b128 v[136:139], v56 offset:12288
ds_read_b128 v[140:143], v56 offset:13312
ds_read_b128 v[144:147], v56 offset:14336
s_waitcnt vmcnt(23)
s_waitcnt lgkmcnt(9)
v_mfma_f32_16x16x32_bf16 v[64:67], v[148:151], a[52:55], v[64:67]
v_mfma_f32_16x16x32_bf16 v[68:71], v[148:151], a[148:151], v[68:71]
s_add_u32 s57, s57, 4096
buffer_load_dwordx4 a[168:171], v6, s[32:35], s57 offen sc1
s_waitcnt lgkmcnt(8)
v_mfma_f32_16x16x32_bf16 v[72:75], v[152:155], a[52:55], v[72:75]
v_mfma_f32_16x16x32_bf16 v[76:79], v[152:155], a[148:151], v[76:79]
s_waitcnt lgkmcnt(7)
v_mfma_f32_16x16x32_bf16 v[80:83], v[156:159], a[52:55], v[80:83]
v_mfma_f32_16x16x32_bf16 v[84:87], v[156:159], a[148:151], v[84:87]
buffer_load_dwordx4 a[76:79], v6, s[32:35], s56 offen offset:3072 sc1
s_waitcnt lgkmcnt(6)
v_mfma_f32_16x16x32_bf16 v[88:91], v[160:163], a[52:55], v[88:91]
v_mfma_f32_16x16x32_bf16 v[92:95], v[160:163], a[148:151], v[92:95]
s_waitcnt lgkmcnt(5)
v_mfma_f32_16x16x32_bf16 v[96:99], v[164:167], a[52:55], v[96:99]
v_mfma_f32_16x16x32_bf16 v[100:103], v[164:167], a[148:151], v[100:103]
s_waitcnt vmcnt(20)
s_barrier
v_add_u32 v56, -61440, v56
ds_read_b128 v[148:151], v56 offset:0
ds_read_b128 v[152:155], v56 offset:1024
ds_read_b128 v[156:159], v56 offset:2048
ds_read_b128 v[160:163], v56 offset:3072
ds_read_b128 v[164:167], v56 offset:4096
s_waitcnt vmcnt(19)
s_waitcnt lgkmcnt(9)
v_mfma_f32_16x16x32_bf16 v[64:67], v[128:131], a[56:59], v[64:67]
v_mfma_f32_16x16x32_bf16 v[68:71], v[128:131], a[152:155], v[68:71]
buffer_load_dwordx4 a[172:175], v6, s[32:35], s57 offen offset:3072 sc1
s_waitcnt lgkmcnt(8)
v_mfma_f32_16x16x32_bf16 v[72:75], v[132:135], a[56:59], v[72:75]
v_mfma_f32_16x16x32_bf16 v[76:79], v[132:135], a[152:155], v[76:79]
s_waitcnt lgkmcnt(7)
v_mfma_f32_16x16x32_bf16 v[80:83], v[136:139], a[56:59], v[80:83]
v_mfma_f32_16x16x32_bf16 v[84:87], v[136:139], a[152:155], v[84:87]
s_add_u32 s56, s56, 4096
buffer_load_dwordx4 a[80:83], v6, s[32:35], s56 offen offset:2048 sc1
s_waitcnt lgkmcnt(6)
v_mfma_f32_16x16x32_bf16 v[88:91], v[140:143], a[56:59], v[88:91]
v_mfma_f32_16x16x32_bf16 v[92:95], v[140:143], a[152:155], v[92:95]
s_waitcnt lgkmcnt(5)
v_mfma_f32_16x16x32_bf16 v[96:99], v[144:147], a[56:59], v[96:99]
v_mfma_f32_16x16x32_bf16 v[100:103], v[144:147], a[152:155], v[100:103]
v_add_u32 v56, -71680, v56
ds_read_b128 v[128:131], v56 offset:0
ds_read_b128 v[132:135], v56 offset:1024
ds_read_b128 v[136:139], v56 offset:2048
ds_read_b128 v[140:143], v56 offset:3072
ds_read_b128 v[144:147], v56 offset:4096
s_barrier
s_waitcnt vmcnt(16)
s_waitcnt lgkmcnt(9)
v_mfma_f32_16x16x32_bf16 v[64:67], v[148:151], a[60:63], v[64:67]
v_mfma_f32_16x16x32_bf16 v[68:71], v[148:151], a[156:159], v[68:71]
s_add_u32 s57, s57, 4096
buffer_load_dwordx4 a[176:179], v6, s[32:35], s57 offen offset:2048 sc1
s_waitcnt lgkmcnt(8)
v_mfma_f32_16x16x32_bf16 v[72:75], v[152:155], a[60:63], v[72:75]
v_mfma_f32_16x16x32_bf16 v[76:79], v[152:155], a[156:159], v[76:79]
s_add_u32 m0, s4, 102400
s_add_u32 s5, s64, 0
buffer_load_dwordx4 v6, s[32:35], s5 offen sc1 lds
s_waitcnt lgkmcnt(7)
v_mfma_f32_16x16x32_bf16 v[80:83], v[156:159], a[60:63], v[80:83]
v_mfma_f32_16x16x32_bf16 v[84:87], v[156:159], a[156:159], v[84:87]
s_add_u32 s56, s56, 4096
buffer_load_dwordx4 a[84:87], v6, s[32:35], s56 offen offset:1024 sc1
s_waitcnt lgkmcnt(6)
v_mfma_f32_16x16x32_bf16 v[88:91], v[160:163], a[60:63], v[88:91]
v_mfma_f32_16x16x32_bf16 v[92:95], v[160:163], a[156:159], v[92:95]
s_add_u32 m0, s4, 106496
s_add_u32 s5, s64, 4096
buffer_load_dwordx4 v6, s[32:35], s5 offen sc1 lds
s_waitcnt lgkmcnt(5)
v_mfma_f32_16x16x32_bf16 v[96:99], v[164:167], a[60:63], v[96:99]
v_mfma_f32_16x16x32_bf16 v[100:103], v[164:167], a[156:159], v[100:103]
s_add_u32 m0, s4, 110592
s_add_u32 s5, s64, 8192
buffer_load_dwordx4 v6, s[32:35], s5 offen sc1 lds
ds_read_b128 v[148:151], v56 offset:10240
ds_read_b128 v[152:155], v56 offset:11264
ds_read_b128 v[156:159], v56 offset:12288
ds_read_b128 v[160:163], v56 offset:13312
ds_read_b128 v[164:167], v56 offset:14336
s_waitcnt vmcnt(16)
s_waitcnt lgkmcnt(9)
v_mfma_f32_16x16x32_bf16 v[64:67], v[128:131], a[64:67], v[64:67]
v_mfma_f32_16x16x32_bf16 v[68:71], v[128:131], a[160:163], v[68:71]
s_add_u32 s57, s57, 4096
buffer_load_dwordx4 a[180:183], v6, s[32:35], s57 offen offset:1024 sc1
s_waitcnt lgkmcnt(8)
v_mfma_f32_16x16x32_bf16 v[72:75], v[132:135], a[64:67], v[72:75]
v_mfma_f32_16x16x32_bf16 v[76:79], v[132:135], a[160:163], v[76:79]
s_add_u32 m0, s4, 114688
s_add_u32 s5, s64, 12288
buffer_load_dwordx4 v6, s[32:35], s5 offen sc1 lds
s_waitcnt lgkmcnt(7)
v_mfma_f32_16x16x32_bf16 v[80:83], v[136:139], a[64:67], v[80:83]
v_mfma_f32_16x16x32_bf16 v[84:87], v[136:139], a[160:163], v[84:87]
s_add_u32 s56, s56, 4096
buffer_load_dwordx4 a[88:91], v6, s[32:35], s56 offen sc1
s_waitcnt lgkmcnt(6)
v_mfma_f32_16x16x32_bf16 v[88:91], v[140:143], a[64:67], v[88:91]
v_mfma_f32_16x16x32_bf16 v[92:95], v[140:143], a[160:163], v[92:95]
s_add_u32 m0, s4, 118784
s_add_u32 s5, s64, 16384
buffer_load_dwordx4 v6, s[32:35], s5 offen sc1 lds
s_waitcnt lgkmcnt(5)
v_mfma_f32_16x16x32_bf16 v[96:99], v[144:147], a[64:67], v[96:99]
v_mfma_f32_16x16x32_bf16 v[100:103], v[144:147], a[160:163], v[100:103]
s_add_u32 m0, s4, 122880
s_add_u32 s5, s64, 20480
buffer_load_dwordx4 v6, s[32:35], s5 offen sc1 lds
ds_read_b128 v[128:131], v56 offset:20480
ds_read_b128 v[132:135], v56 offset:21504
ds_read_b128 v[136:139], v56 offset:22528
ds_read_b128 v[140:143], v56 offset:23552
ds_read_b128 v[144:147], v56 offset:24576
s_waitcnt vmcnt(16)
s_waitcnt lgkmcnt(9)
v_mfma_f32_16x16x32_bf16 v[64:67], v[148:151], a[68:71], v[64:67]
v_mfma_f32_16x16x32_bf16 v[68:71], v[148:151], a[164:167], v[68:71]
s_add_u32 s57, s57, 4096
buffer_load_dwordx4 a[184:187], v6, s[32:35], s57 offen sc1
s_waitcnt lgkmcnt(8)
v_mfma_f32_16x16x32_bf16 v[72:75], v[152:155], a[68:71], v[72:75]
v_mfma_f32_16x16x32_bf16 v[76:79], v[152:155], a[164:167], v[76:79]
s_add_u32 m0, s4, 126976
s_add_u32 s5, s64, 24576
buffer_load_dwordx4 v6, s[32:35], s5 offen sc1 lds
s_waitcnt lgkmcnt(7)
v_mfma_f32_16x16x32_bf16 v[80:83], v[156:159], a[68:71], v[80:83]
v_mfma_f32_16x16x32_bf16 v[84:87], v[156:159], a[164:167], v[84:87]
buffer_load_dwordx4 a[92:95], v6, s[32:35], s56 offen offset:3072 sc1
s_waitcnt lgkmcnt(6)
v_mfma_f32_16x16x32_bf16 v[88:91], v[160:163], a[68:71], v[88:91]
v_mfma_f32_16x16x32_bf16 v[92:95], v[160:163], a[164:167], v[92:95]
s_add_u32 m0, s4, 131072
s_add_u32 s5, s64, 28672
buffer_load_dwordx4 v6, s[32:35], s5 offen sc1 lds
s_waitcnt lgkmcnt(5)
v_mfma_f32_16x16x32_bf16 v[96:99], v[164:167], a[68:71], v[96:99]
v_mfma_f32_16x16x32_bf16 v[100:103], v[164:167], a[164:167], v[100:103]
s_add_u32 m0, s4, 135168
s_add_u32 s5, s64, 32768
buffer_load_dwordx4 v6, s[32:35], s5 offen sc1 lds
ds_read_b128 v[148:151], v56 offset:30720
ds_read_b128 v[152:155], v56 offset:31744
ds_read_b128 v[156:159], v56 offset:32768
ds_read_b128 v[160:163], v56 offset:33792
ds_read_b128 v[164:167], v56 offset:34816
s_waitcnt vmcnt(18)
s_waitcnt lgkmcnt(9)
v_mfma_f32_16x16x32_bf16 v[64:67], v[128:131], a[72:75], v[64:67]
v_mfma_f32_16x16x32_bf16 v[68:71], v[128:131], a[168:171], v[68:71]
buffer_load_dwordx4 a[188:191], v6, s[32:35], s57 offen offset:3072 sc1
s_add_u32 m0, s4, 139264
s_add_u32 s5, s64, 36864
buffer_load_dwordx4 v6, s[32:35], s5 offen sc1 lds
s_waitcnt lgkmcnt(8)
v_mfma_f32_16x16x32_bf16 v[72:75], v[132:135], a[72:75], v[72:75]
v_mfma_f32_16x16x32_bf16 v[76:79], v[132:135], a[168:171], v[76:79]
s_add_u32 m0, s4, 143360
s_add_u32 s5, s64, 40960
buffer_load_dwordx4 v6, s[32:35], s5 offen sc1 lds
s_waitcnt lgkmcnt(7)
v_mfma_f32_16x16x32_bf16 v[80:83], v[136:139], a[72:75], v[80:83]
v_mfma_f32_16x16x32_bf16 v[84:87], v[136:139], a[168:171], v[84:87]
s_add_u32 m0, s4, 147456
s_add_u32 s5, s64, 45056
buffer_load_dwordx4 v6, s[32:35], s5 offen sc1 lds
s_waitcnt lgkmcnt(6)
v_mfma_f32_16x16x32_bf16 v[88:91], v[140:143], a[72:75], v[88:91]
v_mfma_f32_16x16x32_bf16 v[92:95], v[140:143], a[168:171], v[92:95]
s_add_u32 m0, s4, 151552
s_add_u32 s5, s64, 49152
buffer_load_dwordx4 v6, s[32:35], s5 offen sc1 lds
s_waitcnt lgkmcnt(5)
v_mfma_f32_16x16x32_bf16 v[96:99], v[144:147], a[72:75], v[96:99]
v_mfma_f32_16x16x32_bf16 v[100:103], v[144:147], a[168:171], v[100:103]
s_add_u32 m0, s4, 155648
s_add_u32 s5, s64, 53248
buffer_load_dwordx4 v6, s[32:35], s5 offen sc1 lds
s_barrier
ds_read_b128 v[128:131], v56 offset:40960
ds_read_b128 v[132:135], v56 offset:41984
ds_read_b128 v[136:139], v56 offset:43008
ds_read_b128 v[140:143], v56 offset:44032
ds_read_b128 v[144:147], v56 offset:45056
s_waitcnt vmcnt(22)
s_waitcnt lgkmcnt(9)
v_mfma_f32_16x16x32_bf16 v[64:67], v[148:151], a[76:79], v[64:67]
v_mfma_f32_16x16x32_bf16 v[68:71], v[148:151], a[172:175], v[68:71]
s_add_u32 m0, s4, 159744
s_add_u32 s5, s64, 57344
buffer_load_dwordx4 v6, s[32:35], s5 offen sc1 lds
s_waitcnt lgkmcnt(8)
v_mfma_f32_16x16x32_bf16 v[72:75], v[152:155], a[76:79], v[72:75]
v_mfma_f32_16x16x32_bf16 v[76:79], v[152:155], a[172:175], v[76:79]
s_waitcnt lgkmcnt(7)
v_mfma_f32_16x16x32_bf16 v[80:83], v[156:159], a[76:79], v[80:83]
v_mfma_f32_16x16x32_bf16 v[84:87], v[156:159], a[172:175], v[84:87]
s_waitcnt lgkmcnt(6)
v_mfma_f32_16x16x32_bf16 v[88:91], v[160:163], a[76:79], v[88:91]
v_mfma_f32_16x16x32_bf16 v[92:95], v[160:163], a[172:175], v[92:95]
s_waitcnt lgkmcnt(5)
v_mfma_f32_16x16x32_bf16 v[96:99], v[164:167], a[76:79], v[96:99]
v_mfma_f32_16x16x32_bf16 v[100:103], v[164:167], a[172:175], v[100:103]
ds_read_b128 v[148:151], v56 offset:51200
ds_read_b128 v[152:155], v56 offset:52224
ds_read_b128 v[156:159], v56 offset:53248
ds_read_b128 v[160:163], v56 offset:54272
ds_read_b128 v[164:167], v56 offset:55296
s_waitcnt vmcnt(21)
s_waitcnt lgkmcnt(9)
v_mfma_f32_16x16x32_bf16 v[64:67], v[128:131], a[80:83], v[64:67]
v_mfma_f32_16x16x32_bf16 v[68:71], v[128:131], a[176:179], v[68:71]
s_waitcnt lgkmcnt(8)
v_mfma_f32_16x16x32_bf16 v[72:75], v[132:135], a[80:83], v[72:75]
v_mfma_f32_16x16x32_bf16 v[76:79], v[132:135], a[176:179], v[76:79]
s_waitcnt lgkmcnt(7)
v_mfma_f32_16x16x32_bf16 v[80:83], v[136:139], a[80:83], v[80:83]
v_mfma_f32_16x16x32_bf16 v[84:87], v[136:139], a[176:179], v[84:87]
s_waitcnt lgkmcnt(6)
v_mfma_f32_16x16x32_bf16 v[88:91], v[140:143], a[80:83], v[88:91]
v_mfma_f32_16x16x32_bf16 v[92:95], v[140:143], a[176:179], v[92:95]
s_waitcnt lgkmcnt(5)
v_mfma_f32_16x16x32_bf16 v[96:99], v[144:147], a[80:83], v[96:99]
v_mfma_f32_16x16x32_bf16 v[100:103], v[144:147], a[176:179], v[100:103]
ds_read_b128 v[128:131], v56 offset:61440
ds_read_b128 v[132:135], v56 offset:62464
ds_read_b128 v[136:139], v56 offset:63488
ds_read_b128 v[140:143], v56 offset:64512
v_add_u32 v56, 65536, v56
ds_read_b128 v[144:147], v56 offset:0
s_waitcnt vmcnt(16)
s_waitcnt lgkmcnt(9)
v_mfma_f32_16x16x32_bf16 v[64:67], v[148:151], a[84:87], v[64:67]
v_mfma_f32_16x16x32_bf16 v[68:71], v[148:151], a[180:183], v[68:71]
s_waitcnt lgkmcnt(8)
v_mfma_f32_16x16x32_bf16 v[72:75], v[152:155], a[84:87], v[72:75]
v_mfma_f32_16x16x32_bf16 v[76:79], v[152:155], a[180:183], v[76:79]
s_waitcnt lgkmcnt(7)
v_mfma_f32_16x16x32_bf16 v[80:83], v[156:159], a[84:87], v[80:83]
v_mfma_f32_16x16x32_bf16 v[84:87], v[156:159], a[180:183], v[84:87]
s_waitcnt lgkmcnt(6)
v_mfma_f32_16x16x32_bf16 v[88:91], v[160:163], a[84:87], v[88:91]
v_mfma_f32_16x16x32_bf16 v[92:95], v[160:163], a[180:183], v[92:95]
s_waitcnt lgkmcnt(5)
v_mfma_f32_16x16x32_bf16 v[96:99], v[164:167], a[84:87], v[96:99]
v_mfma_f32_16x16x32_bf16 v[100:103], v[164:167], a[180:183], v[100:103]
ds_read_b128 v[148:151], v56 offset:16384
ds_read_b128 v[152:155], v56 offset:17408
ds_read_b128 v[156:159], v56 offset:18432
ds_read_b128 v[160:163], v56 offset:19456
ds_read_b128 v[164:167], v56 offset:20480
s_waitcnt vmcnt(11)
s_waitcnt lgkmcnt(9)
v_mfma_f32_16x16x32_bf16 v[64:67], v[128:131], a[88:91], v[64:67]
v_mfma_f32_16x16x32_bf16 v[68:71], v[128:131], a[184:187], v[68:71]
s_waitcnt lgkmcnt(8)
v_mfma_f32_16x16x32_bf16 v[72:75], v[132:135], a[88:91], v[72:75]
v_mfma_f32_16x16x32_bf16 v[76:79], v[132:135], a[184:187], v[76:79]
s_waitcnt lgkmcnt(7)
v_mfma_f32_16x16x32_bf16 v[80:83], v[136:139], a[88:91], v[80:83]
v_mfma_f32_16x16x32_bf16 v[84:87], v[136:139], a[184:187], v[84:87]
s_waitcnt lgkmcnt(6)
v_mfma_f32_16x16x32_bf16 v[88:91], v[140:143], a[88:91], v[88:91]
v_mfma_f32_16x16x32_bf16 v[92:95], v[140:143], a[184:187], v[92:95]
s_waitcnt lgkmcnt(5)
v_mfma_f32_16x16x32_bf16 v[96:99], v[144:147], a[88:91], v[96:99]
v_mfma_f32_16x16x32_bf16 v[100:103], v[144:147], a[184:187], v[100:103]
s_waitcnt vmcnt(6)
s_waitcnt lgkmcnt(4)
v_mfma_f32_16x16x32_bf16 v[64:67], v[148:151], a[92:95], v[64:67]
v_mfma_f32_16x16x32_bf16 v[68:71], v[148:151], a[188:191], v[68:71]
s_waitcnt lgkmcnt(3)
v_mfma_f32_16x16x32_bf16 v[72:75], v[152:155], a[92:95], v[72:75]
v_mfma_f32_16x16x32_bf16 v[76:79], v[152:155], a[188:191], v[76:79]
s_waitcnt lgkmcnt(2)
v_mfma_f32_16x16x32_bf16 v[80:83], v[156:159], a[92:95], v[80:83]
v_mfma_f32_16x16x32_bf16 v[84:87], v[156:159], a[188:191], v[84:87]
s_waitcnt lgkmcnt(1)
v_mfma_f32_16x16x32_bf16 v[88:91], v[160:163], a[92:95], v[88:91]
v_mfma_f32_16x16x32_bf16 v[92:95], v[160:163], a[188:191], v[92:95]
s_waitcnt lgkmcnt(0)
v_mfma_f32_16x16x32_bf16 v[96:99], v[164:167], a[92:95], v[96:99]
v_mfma_f32_16x16x32_bf16 v[100:103], v[164:167], a[188:191], v[100:103]
v_lshlrev_b32 v170, 4, v5
ds_read_b128 v[216:219], v170 offset:1536
ds_read_b128 v[220:223], v170 offset:1600
ds_read_b128 v[224:227], v170 offset:1664
ds_read_b128 v[228:231], v170 offset:1728
ds_read_b128 v[232:235], v170 offset:1792
s_waitcnt lgkmcnt(0)
v_pk_add_f32 v[16:17], v[16:17], v[216:217]
v_pk_add_f32 v[18:19], v[18:19], v[218:219]
v_pk_add_f32 v[20:21], v[20:21], v[220:221]
v_pk_add_f32 v[22:23], v[22:23], v[222:223]
v_pk_add_f32 v[24:25], v[24:25], v[224:225]
v_pk_add_f32 v[26:27], v[26:27], v[226:227]
v_pk_add_f32 v[28:29], v[28:29], v[228:229]
v_pk_add_f32 v[30:31], v[30:31], v[230:231]
v_pk_add_f32 v[32:33], v[32:33], v[232:233]
v_pk_add_f32 v[34:35], v[34:35], v[234:235]
s_barrier
s_mul_i32 s56, s40, 5120
s_add_u32 s56, s56, 81920
v_add_u32 v168, s56, v6
s_xor_b32 s57, s40, 2
s_mul_i32 s57, s57, 5120
s_add_u32 s57, s57, 81920
v_add_u32 v169, s57, v6
s_cmp_eq_u32 s46, 0
s_nop 3
s_cbranch_scc0 Lrk_72
ds_write_b128 v168, v[68:71] offset:0
ds_write_b128 v168, v[76:79] offset:1024
ds_write_b128 v168, v[84:87] offset:2048
ds_write_b128 v168, v[92:95] offset:3072
ds_write_b128 v168, v[100:103] offset:4096
v_pk_add_f32 v[16:17], v[16:17], v[64:65]
v_pk_add_f32 v[18:19], v[18:19], v[66:67]
v_pk_add_f32 v[20:21], v[20:21], v[72:73]
v_pk_add_f32 v[22:23], v[22:23], v[74:75]
v_pk_add_f32 v[24:25], v[24:25], v[80:81]
v_pk_add_f32 v[26:27], v[26:27], v[82:83]
v_pk_add_f32 v[28:29], v[28:29], v[88:89]
v_pk_add_f32 v[30:31], v[30:31], v[90:91]
v_pk_add_f32 v[32:33], v[32:33], v[96:97]
v_pk_add_f32 v[34:35], v[34:35], v[98:99]
s_nop 4
s_branch Lrk_73
Lrk_72:
ds_write_b128 v168, v[64:67] offset:0
ds_write_b128 v168, v[72:75] offset:1024
ds_write_b128 v168, v[80:83] offset:2048
ds_write_b128 v168, v[88:91] offset:3072
ds_write_b128 v168, v[96:99] offset:4096
v_pk_add_f32 v[16:17], v[16:17], v[68:69]
v_pk_add_f32 v[18:19], v[18:19], v[70:71]
v_pk_add_f32 v[20:21], v[20:21], v[76:77]
v_pk_add_f32 v[22:23], v[22:23], v[78:79]
v_pk_add_f32 v[24:25], v[24:25], v[84:85]
v_pk_add_f32 v[26:27], v[26:27], v[86:87]
v_pk_add_f32 v[28:29], v[28:29], v[92:93]
v_pk_add_f32 v[30:31], v[30:31], v[94:95]
v_pk_add_f32 v[32:33], v[32:33], v[100:101]
v_pk_add_f32 v[34:35], v[34:35], v[102:103]
s_nop 4
Lrk_73:
s_waitcnt lgkmcnt(0)
s_barrier
ds_read_b128 v[176:179], v169 offset:0
ds_read_b128 v[180:183], v169 offset:1024
ds_read_b128 v[184:187], v169 offset:2048
ds_read_b128 v[188:191], v169 offset:3072
ds_read_b128 v[192:195], v169 offset:4096
s_waitcnt lgkmcnt(4)
v_pk_add_f32 v[16:17], v[16:17], v[176:177]
v_pk_add_f32 v[18:19], v[18:19], v[178:179]
s_waitcnt lgkmcnt(3)
v_pk_add_f32 v[20:21], v[20:21], v[180:181]
v_pk_add_f32 v[22:23], v[22:23], v[182:183]
s_waitcnt lgkmcnt(2)
v_pk_add_f32 v[24:25], v[24:25], v[184:185]
v_pk_add_f32 v[26:27], v[26:27], v[186:187]
s_waitcnt lgkmcnt(1)
v_pk_add_f32 v[28:29], v[28:29], v[188:189]
v_pk_add_f32 v[30:31], v[30:31], v[190:191]
s_waitcnt lgkmcnt(0)
v_pk_add_f32 v[32:33], v[32:33], v[192:193]
v_pk_add_f32 v[34:35], v[34:35], v[194:195]
s_cmp_eq_u32 s47, 1
s_nop 3
s_cbranch_scc1 Lfin_74
s_lshl_b32 s62, s9, 1
s_add_u32 s62, s62, s48
s_add_u32 s62, s62, 16777216
s_add_u32 s63, s49, 3407872
v_cvt_pk_bf16_f32 v176, v20, v21
v_cvt_pk_bf16_f32 v177, v22, v23
v_cvt_pk_bf16_f32 v178, v16, v17
v_cvt_pk_bf16_f32 v179, v18, v19
v_cvt_pk_bf16_f32 v180, v28, v29
v_cvt_pk_bf16_f32 v181, v30, v31
v_cvt_pk_bf16_f32 v182, v24, v25
v_cvt_pk_bf16_f32 v183, v26, v27
v_cvt_pk_bf16_f32 v184, v32, v33
v_cvt_pk_bf16_f32 v185, v34, v35
v_permlane16_swap_b32 v176, v178
v_permlane16_swap_b32 v177, v179
v_permlane16_swap_b32 v180, v182
v_permlane16_swap_b32 v181, v183
s_cmp_eq_u32 s83, 1
s_nop 3
s_cbranch_scc1 Lst_75
buffer_store_dwordx4 v[176:179], v7, s[32:35], s62 offen sc1
buffer_store_dwordx4 v[180:183], v7, s[32:35], s62 offen offset:2048 sc1
buffer_store_dwordx2 v[184:185], v8, s[32:35], s62 offen sc1
s_nop 0
s_branch Lst_76
Lst_75:
buffer_store_dwordx4 v[176:179], v7, s[32:35], s62 offen
buffer_store_dwordx4 v[180:183], v7, s[32:35], s62 offen offset:2048
buffer_store_dwordx2 v[184:185], v8, s[32:35], s62 offen
s_nop 0
Lst_76:
v_pk_add_f32 v[186:187], v[16:17], v[18:19]
v_pk_mul_f32 v[188:189], v[16:17], v[16:17]
v_pk_fma_f32 v[188:189], v[18:19], v[18:19], v[188:189]
v_pk_add_f32 v[186:187], v[186:187], v[20:21]
v_pk_fma_f32 v[188:189], v[20:21], v[20:21], v[188:189]
v_pk_add_f32 v[186:187], v[186:187], v[22:23]
v_pk_fma_f32 v[188:189], v[22:23], v[22:23], v[188:189]
v_pk_add_f32 v[186:187], v[186:187], v[24:25]
v_pk_fma_f32 v[188:189], v[24:25], v[24:25], v[188:189]
v_pk_add_f32 v[186:187], v[186:187], v[26:27]
v_pk_fma_f32 v[188:189], v[26:27], v[26:27], v[188:189]
v_pk_add_f32 v[186:187], v[186:187], v[28:29]
v_pk_fma_f32 v[188:189], v[28:29], v[28:29], v[188:189]
v_pk_add_f32 v[186:187], v[186:187], v[30:31]
v_pk_fma_f32 v[188:189], v[30:31], v[30:31], v[188:189]
v_pk_add_f32 v[186:187], v[186:187], v[32:33]
v_pk_fma_f32 v[188:189], v[32:33], v[32:33], v[188:189]
v_pk_add_f32 v[186:187], v[186:187], v[34:35]
v_pk_fma_f32 v[188:189], v[34:35], v[34:35], v[188:189]
v_add_f32 v186, v186, v187
v_add_f32 v187, v188, v189
v_mov_b32 v188, v186
v_mov_b32 v189, v187
s_nop 0
v_permlane16_swap_b32 v186, v188
v_permlane16_swap_b32 v187, v189
v_add_f32 v186, v186, v188
v_add_f32 v187, v187, v189
v_mov_b32 v188, v186
v_mov_b32 v189, v187
s_nop 0
v_permlane32_swap_b32 v186, v188
v_permlane32_swap_b32 v187, v189
v_add_f32 v186, v186, v188
v_add_f32 v187, v187, v189
buffer_store_dwordx2 v[186:187], v9, s[32:35], s63 offen sc1
s_waitcnt vmcnt(0)
s_cmp_eq_u32 s83, 1
s_nop 1
s_cbranch_scc0 Larr_78
s_lshr_b32 s91, s87, 4
s_add_u32 s91, s91, 5
s_mov_b64 exec, 1
v_mov_b32 v168, s3
v_mov_b32 v169, s91
global_store_dword v168, v169, s[30:31]
s_mov_b64 exec, -1
s_nop 2
s_branch Larr_77
Larr_78:
s_barrier
s_cmp_eq_u32 s40, 0
s_cbranch_scc0 Larr_77
s_mov_b64 exec, 1
v_mov_b32 v168, s84
global_atomic_add v168, v11, s[30:31] sc1
s_mov_b64 exec, -1
s_nop 2
Larr_77:
s_lshr_b32 s91, s87, 4
s_add_u32 s91, s91, 5
s_cmp_eq_u32 s83, 1
s_cbranch_scc1 Lpf_79
s_cmp_eq_u32 s40, 1
s_cbranch_scc0 Lps_81
s_lshl_b32 s91, s91, 4
v_mov_b32 v168, s84
v_mov_b32 v169, s91
v_mov_b32 v171, 0xff
s_mov_b64 exec, 1
s_cmp_eq_u32 s53, 0
s_cselect_b32 s82, 0, 6000000
s_nop 1
Lp_82:
global_load_dword v170, v168, s[30:31] sc1
s_add_u32 s82, s82, 1
s_cmp_gt_u32 s82, 6000000
s_cbranch_scc1 Lpd_83_to
s_waitcnt vmcnt(0)
v_and_b32 v172, v171, v170
v_cmp_lt_u32 vcc, v172, v169
s_nop 4
s_cbranch_vccz Lpd_83
s_branch Lp_82
Lpd_83_to:
s_or_b32 s53, s53, 128
s_waitcnt vmcnt(0)
Lpd_83:
s_mov_b64 exec, -1
Lps_81:
s_barrier
s_branch Lpg_80
Lpf_79:
s_lshl_b32 s79, s41, 8
s_add_u32 s79, s79, 16384
v_lshlrev_b32 v168, 2, v1
v_add_u32 v168, s79, v168
v_mov_b32 v169, s91
v_mov_b32 v171, -1
s_cmp_eq_u32 s53, 0
s_cselect_b32 s82, 0, 6000000
s_nop 2
Lp_84:
global_load_dword v170, v168, s[30:31] sc1
s_add_u32 s82, s82, 1
s_cmp_gt_u32 s82, 6000000
s_cbranch_scc1 Lpd_85_to
s_waitcnt vmcnt(0)
v_and_b32 v172, v171, v170
v_cmp_lt_u32 vcc, v172, v169
s_nop 4
s_cbranch_vccz Lpd_85
s_branch Lp_84
Lpd_85_to:
s_or_b32 s53, s53, 128
s_waitcnt vmcnt(0)
Lpd_85:
Lpg_80:
s_mov_b32 s47, 1
s_mov_b32 s87, 64
s_cmp_eq_u32 s83, 1
s_cselect_b32 s8, 0, s47
s_cselect_b32 s9, 0, 4194304
s_and_b32 s10, s83, s47
s_branch L_layer
Lfin_74:
v_cvt_pk_bf16_f32 v176, v20, v21
v_cvt_pk_bf16_f32 v177, v22, v23
v_cvt_pk_bf16_f32 v178, v16, v17
v_cvt_pk_bf16_f32 v179, v18, v19
v_cvt_pk_bf16_f32 v180, v28, v29
v_cvt_pk_bf16_f32 v181, v30, v31
v_cvt_pk_bf16_f32 v182, v24, v25
v_cvt_pk_bf16_f32 v183, v26, v27
v_cvt_pk_bf16_f32 v184, v32, v33
v_cvt_pk_bf16_f32 v185, v34, v35
v_permlane16_swap_b32 v176, v178
v_permlane16_swap_b32 v177, v179
v_permlane16_swap_b32 v180, v182
v_permlane16_swap_b32 v181, v183
s_mov_b32 s36, s26
s_mov_b32 s37, s27
s_mov_b32 s38, 2621440
s_mov_b32 s39, 0x20000
v_mul_u32_u24 v168, 1280, v4
v_and_b32 v169, 1, v5
v_xor_b32 v169, 1, v169
v_lshlrev_b32 v169, 5, v169
v_lshrrev_b32 v170, 1, v5
v_lshlrev_b32 v170, 4, v170
v_add3_u32 v169, v168, v169, v170
v_lshlrev_b32 v170, 3, v5
v_add_u32 v170, v168, v170
s_mul_i32 s56, s50, 1280
s_mul_i32 s57, s44, 160
s_add_u32 s56, s56, s57
buffer_store_dwordx4 v[176:179], v169, s[36:39], s56 offen
buffer_store_dwordx4 v[180:183], v169, s[36:39], s56 offen offset:64
buffer_store_dwordx2 v[184:185], v170, s[36:39], s56 offen offset:128
s_cmp_eq_u32 s53, 0
s_cbranch_scc1 Lerr_86
v_mov_b32 v168, 64
v_mov_b32 v169, s53
global_atomic_or v168, v169, s[28:29]
s_nop 3
Lerr_86:
L_end:
s_endpgm
.section .rodata,"a"
.p2align 6
.amdhsa_kernel interleave_layers__linear_kernel_hedgehog__mixer_channel_mlp__prompt_kernel
  .amdhsa_next_free_vgpr 512
  .amdhsa_next_free_sgpr 102
  .amdhsa_accum_offset 256
  .amdhsa_group_segment_fixed_size 0
  .amdhsa_kernarg_size 96
  .amdhsa_user_sgpr_count 2
  .amdhsa_user_sgpr_kernarg_segment_ptr 1
  .amdhsa_system_sgpr_workgroup_id_x 1
  .amdhsa_float_denorm_mode_32 3
  .amdhsa_float_denorm_mode_16_64 3
.end_amdhsa_kernel
```
